```python
import torch

def _softmax(x, axis=-1):
    return torch.softmax(x, dim=axis)
def _gelu(x):
    return torch.nn.functional.gelu(x, approximate="tanh")
def _silu(x):
    return torch.nn.functional.silu(x)
def _sigmoid(x):
    return torch.sigmoid(x)
def _layernorm(x, axis=-1, eps=1e-5):
    m = x.mean(dim=axis, keepdim=True)
    v = x.var(dim=axis, keepdim=True, unbiased=False)
    return (x - m) / torch.sqrt(v + eps)
def _scatter_add(tgt, idx, src, axis=0):
    return tgt.clone().index_add_(axis, idx, src)
def _segment_sum(src, seg, n):
    out = torch.zeros((n,) + src.shape[1:], dtype=src.dtype)
    return out.index_add_(0, seg, src)
def _pad(x, pw):
    flat = tuple(v for pair in reversed(pw) for v in pair)
    return torch.nn.functional.pad(x, flat)

kernel_name = 'recurrent_scan__ssm_conv_h3__dense_activation_relu__prompt'

def setup_inputs():

    _w = (lambda a: (lambda t: t.to(torch.bfloat16) if t.is_floating_point() else t)(torch.as_tensor(a)))
    def _A_setup():
        B, S, D = 1, 2048, 640
        ks = 4
        return {
            "q": _w((lambda *s: torch.randn(*s, dtype=torch.bfloat16) * 0.05)(B, S, D)),
            "k": _w((lambda *s: torch.randn(*s, dtype=torch.bfloat16) * 0.2)(B, S, D)),
            "v": _w((lambda *s: torch.randn(*s, dtype=torch.bfloat16) * 0.2)(B, S, D)),
            "shift_k": _w((lambda *s: torch.randn(*s, dtype=torch.bfloat16) * 0.2)(D, ks) * 0.5),
            "ssm_k": _w((lambda *s: torch.randn(*s, dtype=torch.bfloat16) * 0.2)(D, S) * (1.0 / S ** 0.5)),
            "ssm_D": _w((lambda *s: torch.randn(*s, dtype=torch.bfloat16) * 0.2)(D)),
        }
    _A_in = _A_setup()

    def _B_setup():
        B, S, D, Dff = 1, 2048, 640, 1728
        return {
            "x": _w((lambda *s: torch.randn(*s, dtype=torch.bfloat16) * 0.05)(B, S, D)),
            "w1": _w((lambda *s: torch.randn(*s, dtype=torch.bfloat16) * 0.1)(D, Dff)),
            "w2": _w((lambda *s: torch.randn(*s, dtype=torch.bfloat16) * 0.1)(Dff, D)),
        }
    _B_in = _B_setup()

    return {
        "A_q": _A_in["q"],
        "A_k": _A_in["k"],
        "A_v": _A_in["v"],
        "A_shift_k": _A_in["shift_k"],
        "A_ssm_k": _A_in["ssm_k"],
        "A_ssm_D": _A_in["ssm_D"],
        "B_x": _B_in["x"],
        "B_w1": _B_in["w1"],
        "B_w2": _B_in["w2"],
    }

def reference(A_q, A_k, A_v, A_shift_k, A_ssm_k, A_ssm_D, B_x, B_w1, B_w2):
    def _A_ref(q, k, v, shift_k, ssm_k, ssm_D):
        B, S, D = q.shape
        ks = shift_k.shape[-1]
        k_pad = _pad(k, ((0, 0), (ks - 1, 0), (0, 0)))
        k_shift = torch.zeros_like(k)
        for t in range(ks):
            k_shift = k_shift + k_pad[:, t:t + S, :] * shift_k[:, ks - 1 - t][None, None, :]
        kv = k_shift * v
        L = 2 * S
        kv_pad = _pad(kv, ((0, 0), (0, S), (0, 0)))
        kf_pad = _pad(ssm_k, ((0, 0), (0, S)))
        kv_f = (lambda x, axes=(-2,-1): torch.fft.rfft2(x.float(), dim=axes))(kv_pad[:, None, :, :], axes=(1, 2))
        kf_f = (lambda x, axes=(-2,-1): torch.fft.rfft2(x.float(), dim=axes))(kf_pad[:, None, :], axes=(1, 2))
        kf_f = (lambda x, *d: x.permute(*d))(kf_f, 1, 2, 0)
        y_f = kv_f * kf_f[None, :, :, :]
        y = (lambda x, s, axes=(-2,-1): torch.fft.irfft2(x, s=s, dim=axes).to(torch.bfloat16))(y_f, (1, L), axes=(1, 2))[:, 0, :S, :]
        y = y + kv * ssm_D[None, None, :]
        return q * y

    def _B_ref(x, w1, w2):
        h = torch.einsum("bsd,df->bsf", x, w1)
        zero = torch.zeros_like(h)
        h = torch.maximum(h, zero)
        return torch.einsum("bsf,fd->bsd", h, w2)

    x = A_q
    xn = _layernorm(x, axis=-1)
    s = _A_ref(xn, A_k, A_v, A_shift_k, A_ssm_k, A_ssm_D)
    g = _silu(_B_ref(xn, B_w1, B_w2))
    return x + s * g
```

```asm
; @launch grid=(256,1,1) block=(512,1,1) lds=163840
.amdgcn_target "amdgcn-amd-amdhsa--gfx950"
.text
.globl recurrent_scan__ssm_conv_h3__dense_activation_relu__prompt_kernel
.p2align 8
.type recurrent_scan__ssm_conv_h3__dense_activation_relu__prompt_kernel,@function
recurrent_scan__ssm_conv_h3__dense_activation_relu__prompt_kernel:
    s_cmp_ge_u32 s2, 256
    s_cbranch_scc1 L_end
    s_load_dwordx16 s[64:79], s[0:1], 0
    s_load_dwordx8 s[80:87], s[0:1], 64
    v_lshrrev_b32 v3, 6, v0
    s_and_b32 s50, s2, 7
    v_readfirstlane_b32 s7, v3
    s_lshr_b32 s51, s2, 3
    v_and_b32 v1, 63, v0
    v_and_b32 v0, 255, v0
    s_and_b32 s52, s7, 3
    s_cmp_lg_u32 s7, 7
    s_cbranch_scc1 L_nopf
    s_getpc_b64 s[60:61]
    v_and_b32 v2, 15, v0
    v_lshlrev_b32 v2, 12, v2
    s_lshl_b32 s62, s51, 7
    v_add_u32 v2, s62, v2
    v_min_u32 v2, 32780, v2
    global_load_dword v31, v2, s[60:61]
L_nopf:
    s_lshl_b32 s60, s7, 2
    s_add_u32 s60, s60, 163776
    v_mov_b32 v26, 0
    v_mov_b32 v27, s60
    s_xor_b32 s60, s60, 8
    v_mov_b32 v28, s60
    ds_write2_b32 v27, v26, v26 offset0:0 offset1:8
    v_mov_b32 v29, 163768
    ds_write2_b32 v29, v26, v26 offset0:0 offset1:1
    v_lshlrev_b32 v2, 4, v1
    v_add_u32 v3, 4096, v2
    s_mov_b32 s99, 0
    s_and_b32 s97, s50, 1
    s_lshr_b32 s56, s50, 1
    s_lshl_b32 s56, s56, 2
    s_lshr_b32 s59, s51, 3
    s_add_u32 s56, s56, s59
    s_lshl_b32 s56, s56, 1
    s_add_u32 s56, s56, s97
    s_and_b32 s57, s51, 7
    s_waitcnt lgkmcnt(0)
    s_load_dwordx2 s[48:49], s[86:87], 0
    s_cmp_ge_u32 s51, 28
    s_cbranch_scc1 L_p
    s_cmp_ge_u32 s7, 4
    s_cbranch_scc1 L_g1l
    s_mov_b64 s[16:17], s[68:69]
    s_mov_b32 s18, 2621440
    s_mov_b32 s19, 0x20000
    s_mov_b64 s[12:13], s[66:67]
    s_mov_b32 s14, 2621440
    s_mov_b32 s15, 0x20000
    s_mov_b64 s[40:41], s[70:71]
    s_mov_b32 s42, 5120
    s_mov_b32 s43, 0x20000
    s_lshr_b32 s94, s2, 5
    s_and_b32 s93, s2, 31
    s_mul_i32 s62, s93, 81920
    s_lshl_b32 s63, s94, 7
    s_add_u32 s62, s62, s63
    v_lshrrev_b32 v48, 3, v1
    v_mul_u32_u24 v48, 1280, v48
    v_and_b32 v49, 7, v1
    s_lshl_b32 s63, s52, 1
    v_xor_b32 v50, s63, v49
    v_lshl_add_u32 v50, v50, 4, v48
    s_mul_i32 s63, s52, 20480
    s_add_u32 s63, s63, s62
    s_lshl_b32 s59, s52, 11
    s_add_u32 m0, s59, 107520
    v_xor_b32 v51, 16, v50
    buffer_load_dwordx4 v50, s[16:19], s63 offen nt lds
    s_add_u32 m0, s59, 99328
    s_nop 0
    buffer_load_dwordx4 v51, s[12:15], s63 offen nt lds
    s_add_u32 m0, s59, 107520
    v_add_u32 v51, 9216, v51
    buffer_load_dwordx4 v51, s[16:19], s63 offen offset:1024 nt lds
    s_lshl_b32 s60, s52, 1
    s_add_u32 s60, s60, 2
    s_and_b32 s60, s60, 7
    v_xor_b32 v50, s60, v49
    v_lshl_add_u32 v50, v50, 4, v48
    v_add_u32 v50, 9216, v50
    s_add_u32 m0, s59, 99328
    s_lshl_b32 s61, s94, 9
    buffer_load_dwordx4 v50, s[12:15], s63 offen offset:1024 nt lds
    s_cmp_lg_u32 s52, 0
    s_cbranch_scc1 L_nohalo_1
    v_lshl_add_u32 v50, v49, 4, v48
    v_add_u32 v50, s62, v50
    v_subrev_u32 v50, 10240, v50
    v_cmp_gt_u32 vcc, 40, v1
    s_mov_b32 m0, 98304
    v_mov_b32 v51, 0x80000000
    v_cndmask_b32 v50, v50, v51, vcc
    buffer_load_dwordx4 v50, s[12:15], 0 offen lds
L_nohalo_1:
    v_lshrrev_b32 v51, 3, v0
    v_lshlrev_b32 v51, 4, v51
    buffer_load_dwordx4 v[52:55], v51, s[40:43], s61 offen
    s_barrier
    s_mul_i32 s62, s51, 37
    s_lshr_b32 s62, s62, 8
    s_mul_i32 s63, s62, 7
    s_sub_u32 s63, s51, s63
    s_lshr_b32 s61, s50, 1
    s_lshl_b32 s53, s61, 2
    s_add_u32 s53, s53, s62
    s_mul_i32 s54, s97, 7
    s_add_u32 s54, s54, s63
    s_lshl_b32 s55, s54, 7
    s_min_u32 s55, s55, 1600
    s_mul_i32 s6, s61, 5
    s_add_u32 s6, s6, 1
    s_lshr_b32 s6, s6, 1
    s_add_u32 s62, s62, s63
    s_and_b32 s62, s62, 1
    s_mul_i32 s62, s62, 5
    s_add_u32 s6, s6, s62
    s_cmp_ge_u32 s6, 10
    s_cselect_b32 s62, 10, 0
    s_sub_u32 s6, s6, s62
    s_mov_b64 s[36:37], s[86:87]
    s_mov_b32 s38, 268435456
    s_mov_b32 s39, 0x20000
    s_mov_b64 s[8:9], s[64:65]
    s_mov_b32 s10, 2621440
    s_mov_b32 s11, 0x20000
    s_lshl_b32 s60, s53, 7
    s_lshl_b32 s61, s97, 6
    s_add_u32 s60, s60, s61
    s_mul_i32 s61, s52, 7
    s_add_u32 s61, s61, s63
    s_lshl_b32 s62, s61, 2
    s_add_u32 s96, s60, s62
    s_cmp_ge_u32 s61, 16
    s_cselect_b32 s96, 0x1100000, s96
    s_mul_i32 s60, s96, 1280
    v_lshrrev_b32 v56, 4, v1
    v_mul_u32_u24 v56, 1280, v56
    v_and_b32 v57, 15, v1
    v_lshl_add_u32 v56, v57, 4, v56
    buffer_load_dwordx4 v[232:235], v56, s[8:11], s60 offen offset:0
    buffer_load_dwordx4 v[236:239], v56, s[8:11], s60 offen offset:256
    buffer_load_dwordx4 v[240:243], v56, s[8:11], s60 offen offset:512
    buffer_load_dwordx4 v[244:247], v56, s[8:11], s60 offen offset:768
    buffer_load_dwordx4 v[248:251], v56, s[8:11], s60 offen offset:1024
    s_lshr_b32 s6, s52, 1
    s_and_b32 s5, s52, 1
    v_and_b32 v4, 15, v1
    v_lshrrev_b32 v5, 4, v1
    v_and_b32 v6, 7, v1
    v_xor_b32 v6, v5, v6
    s_lshl_b32 s63, s6, 13
    v_lshlrev_b32 v7, 7, v4
    v_add_u32 v7, s63, v7
    v_lshl_add_u32 v32, v6, 4, v7
    v_xor_b32 v33, 64, v32
    v_add_u32 v34, 0x10000, v32
    v_add_u32 v35, 0x10000, v33
    v_lshrrev_b32 v6, 2, v4
    v_and_b32 v7, 1, v5
    v_lshl_or_b32 v7, v7, 2, v6
    v_lshl_add_u32 v8, v5, 3, v6
    v_lshlrev_b32 v8, 8, v8
    v_and_b32 v9, 3, v1
    v_lshl_add_u32 v8, v9, 3, v8
    v_add_u32 v8, 16384, v8
    s_lshl_b32 s63, s5, 2
    v_xor_b32 v7, s63, v7
    v_xor_b32 v9, 0, v7
    v_lshl_add_u32 v36, v9, 5, v8
    v_add_u32 v40, 0x10000, v36
    v_xor_b32 v9, 1, v7
    v_lshl_add_u32 v37, v9, 5, v8
    v_add_u32 v41, 0x10000, v37
    v_xor_b32 v9, 2, v7
    v_lshl_add_u32 v38, v9, 5, v8
    v_add_u32 v42, 0x10000, v38
    v_xor_b32 v9, 3, v7
    v_lshl_add_u32 v39, v9, 5, v8
    v_add_u32 v43, 0x10000, v39
    s_lshl_b32 s60, s6, 8
    s_add_u32 s60, s60, 158720
    v_lshl_add_u32 v21, v4, 2, s60
    s_lshl_b32 s60, s5, 8
    s_add_u32 s60, s60, 159232
    v_lshl_add_u32 v22, v5, 4, s60
    s_lshl_b32 s4, s53, 1
    s_add_u32 s4, s4, s6
    s_mul_i32 s63, s4, 54
    s_lshr_b32 s60, s55, 5
    s_add_u32 s63, s63, s60
    s_lshl_b32 s60, s5, 1
    s_add_u32 s63, s63, s60
    s_lshl_b32 s63, s63, 12
    s_add_u32 s63, s63, 8519680
    s_lshr_b32 s62, s55, 6
    s_add_u32 s62, s62, s5
    s_lshl_b32 s60, s54, 1
    s_add_u32 s60, s60, s5
    s_cmp_eq_u32 s60, 26
    s_cselect_b32 s3, 0x80000000, s63
    s_cselect_b32 s62, 67108864, s62
    s_lshl_b32 s4, s4, 5
    s_add_u32 s62, s62, s4
    s_lshl_b32 s62, s62, 5
    s_add_u32 s90, s62, 262144
    s_mov_b32 s95, 0
    v_and_b32 v132, 7, v0
    v_lshrrev_b32 v133, 5, v0
    v_bfe_u32 v134, v0, 3, 2
    v_xor_b32 v135, v133, v132
    v_lshlrev_b32 v135, 4, v135
    v_lshl_add_u32 v135, v134, 2, v135
    v_lshl_add_u32 v129, v132, 10, v135
    v_add_u32 v130, 107520, v129
    v_add_u32 v129, 98304, v129
    v_add_u32 v136, 1, v132
    v_and_b32 v137, 7, v136
    v_xor_b32 v137, v133, v137
    v_lshlrev_b32 v137, 4, v137
    v_lshl_add_u32 v137, v134, 2, v137
    v_lshl_add_u32 v128, v136, 10, v137
    v_add_u32 v128, 98304, v128
    s_waitcnt lgkmcnt(0)
    s_add_u32 s48, s48, 0x7F4A7C15
    s_addc_u32 s49, s49, 0x9E3779B9
    v_mov_b32 v24, s48
    v_mov_b32 v25, s49
    s_waitcnt vmcnt(5)
    s_add_u32 s99, s99, 1
    v_mov_b32 v29, s99
    ds_write_b32 v27, v29
    v_and_b32 v30, 3, v1
    v_lshlrev_b32 v30, 2, v30
    v_and_b32 v31, -16, v27
    v_add_u32 v30, v30, v31
    s_mov_b32 s59, 1000000
L_qs_2:
    ds_read_b32 v29, v30
    s_waitcnt lgkmcnt(0)
    v_cmp_gt_u32 vcc, s99, v29
    s_cbranch_vccz L_qsd_3
    s_sleep 1
    s_sub_u32 s59, s59, 1
    s_cbranch_scc0 L_qs_2
L_qsd_3:
    ds_read2_b32 v[132:133], v129 offset0:128 offset1:160
    ds_read2_b32 v[134:135], v129 offset0:192 offset1:224
    ds_read2_b32 v[136:137], v128 offset0:0 offset1:32
    ds_read2_b32 v[138:139], v128 offset0:64 offset1:96
    ds_read2_b32 v[140:141], v128 offset0:128 offset1:160
    ds_read2_b32 v[142:143], v128 offset0:192 offset1:224
    ds_read2_b32 v[148:149], v130 offset0:0 offset1:32
    ds_read2_b32 v[150:151], v130 offset0:64 offset1:96
    ds_read2_b32 v[152:153], v130 offset0:128 offset1:160
    ds_read2_b32 v[154:155], v130 offset0:192 offset1:224
    v_mov_b32 v23, 0xffff0000
    v_lshlrev_b32 v156, 16, v52
    v_lshlrev_b32 v157, 16, v54
    v_and_b32 v158, v23, v52
    v_and_b32 v159, v23, v54
    v_lshlrev_b32 v160, 16, v53
    v_lshlrev_b32 v161, 16, v55
    v_and_b32 v162, v23, v53
    v_and_b32 v163, v23, v55
    v_and_b32 v129, 7, v0
    v_sub_u32 v129, 7, v129
    v_lshlrev_b32 v129, 4, v129
    v_lshrrev_b32 v128, 3, v0
    v_lshl_add_u32 v129, v128, 13, v129
    v_add_u32 v128, 4096, v129
    s_waitcnt lgkmcnt(4)
    v_lshlrev_b32 v164, 16, v133
    v_and_b32 v165, v23, v133
    v_lshlrev_b32 v166, 16, v134
    v_and_b32 v167, v23, v134
    v_lshlrev_b32 v168, 16, v135
    v_and_b32 v169, v23, v135
    v_lshlrev_b32 v170, 16, v136
    v_and_b32 v171, v23, v136
    v_lshlrev_b32 v172, 16, v137
    v_and_b32 v173, v23, v137
    v_lshlrev_b32 v174, 16, v138
    v_and_b32 v175, v23, v138
    v_lshlrev_b32 v176, 16, v139
    v_and_b32 v177, v23, v139
    v_lshlrev_b32 v178, 16, v140
    v_and_b32 v179, v23, v140
    v_lshlrev_b32 v180, 16, v141
    v_and_b32 v181, v23, v141
    v_lshlrev_b32 v182, 16, v142
    v_and_b32 v183, v23, v142
    v_lshlrev_b32 v184, 16, v143
    v_and_b32 v185, v23, v143
    v_pk_mul_f32 v[132:133], v[162:163], v[164:165]
    v_pk_mul_f32 v[134:135], v[162:163], v[166:167]
    v_pk_mul_f32 v[136:137], v[162:163], v[168:169]
    v_pk_mul_f32 v[138:139], v[162:163], v[170:171]
    v_pk_mul_f32 v[140:141], v[162:163], v[172:173]
    v_pk_mul_f32 v[142:143], v[162:163], v[174:175]
    v_pk_mul_f32 v[144:145], v[162:163], v[176:177]
    v_pk_mul_f32 v[146:147], v[162:163], v[178:179]
    s_waitcnt lgkmcnt(0)
    v_pk_fma_f32 v[132:133], v[160:161], v[166:167], v[132:133]
    v_pk_fma_f32 v[134:135], v[160:161], v[168:169], v[134:135]
    v_pk_fma_f32 v[136:137], v[160:161], v[170:171], v[136:137]
    v_pk_fma_f32 v[138:139], v[160:161], v[172:173], v[138:139]
    v_pk_fma_f32 v[140:141], v[160:161], v[174:175], v[140:141]
    v_pk_fma_f32 v[142:143], v[160:161], v[176:177], v[142:143]
    v_pk_fma_f32 v[144:145], v[160:161], v[178:179], v[144:145]
    v_pk_fma_f32 v[146:147], v[160:161], v[180:181], v[146:147]
    v_pk_fma_f32 v[132:133], v[158:159], v[168:169], v[132:133]
    v_pk_fma_f32 v[134:135], v[158:159], v[170:171], v[134:135]
    v_pk_fma_f32 v[136:137], v[158:159], v[172:173], v[136:137]
    v_pk_fma_f32 v[138:139], v[158:159], v[174:175], v[138:139]
    v_pk_fma_f32 v[140:141], v[158:159], v[176:177], v[140:141]
    v_pk_fma_f32 v[142:143], v[158:159], v[178:179], v[142:143]
    v_pk_fma_f32 v[144:145], v[158:159], v[180:181], v[144:145]
    v_pk_fma_f32 v[146:147], v[158:159], v[182:183], v[146:147]
    v_pk_fma_f32 v[132:133], v[156:157], v[170:171], v[132:133]
    v_pk_fma_f32 v[134:135], v[156:157], v[172:173], v[134:135]
    v_pk_fma_f32 v[136:137], v[156:157], v[174:175], v[136:137]
    v_pk_fma_f32 v[138:139], v[156:157], v[176:177], v[138:139]
    v_pk_fma_f32 v[140:141], v[156:157], v[178:179], v[140:141]
    v_pk_fma_f32 v[142:143], v[156:157], v[180:181], v[142:143]
    v_pk_fma_f32 v[144:145], v[156:157], v[182:183], v[144:145]
    v_pk_fma_f32 v[146:147], v[156:157], v[184:185], v[146:147]
    v_lshlrev_b32 v164, 16, v148
    v_and_b32 v165, v23, v148
    v_lshlrev_b32 v166, 16, v149
    v_and_b32 v167, v23, v149
    v_lshlrev_b32 v168, 16, v150
    v_and_b32 v169, v23, v150
    v_lshlrev_b32 v170, 16, v151
    v_and_b32 v171, v23, v151
    v_lshlrev_b32 v172, 16, v152
    v_and_b32 v173, v23, v152
    v_lshlrev_b32 v174, 16, v153
    v_and_b32 v175, v23, v153
    v_lshlrev_b32 v176, 16, v154
    v_and_b32 v177, v23, v154
    v_lshlrev_b32 v178, 16, v155
    v_and_b32 v179, v23, v155
    v_pk_mul_f32 v[132:133], v[132:133], v[164:165]
    v_pk_mul_f32 v[134:135], v[134:135], v[166:167]
    v_pk_mul_f32 v[136:137], v[136:137], v[168:169]
    v_pk_mul_f32 v[138:139], v[138:139], v[170:171]
    v_pk_mul_f32 v[140:141], v[140:141], v[172:173]
    v_pk_mul_f32 v[142:143], v[142:143], v[174:175]
    v_pk_mul_f32 v[144:145], v[144:145], v[176:177]
    v_pk_mul_f32 v[146:147], v[146:147], v[178:179]
    s_lshl_b32 s62, s94, 18
    s_lshl_b32 s63, s93, 7
    s_sub_u32 s62, s62, s63
    s_add_u32 s63, s62, 1052544
    s_lshl_b32 s62, s94, 5
    s_add_u32 s62, s62, s93
    s_lshl_b32 s62, s62, 3
    s_add_u32 s88, s62, 720896
    v_cvt_pk_bf16_f32 v156, v146, v144
    v_cvt_pk_bf16_f32 v157, v142, v140
    v_cvt_pk_bf16_f32 v158, v138, v136
    v_cvt_pk_bf16_f32 v159, v134, v132
    v_cvt_pk_bf16_f32 v160, v147, v145
    v_cvt_pk_bf16_f32 v161, v143, v141
    v_cvt_pk_bf16_f32 v162, v139, v137
    v_cvt_pk_bf16_f32 v163, v135, v133
    buffer_store_dwordx4 v[156:159], v129, s[36:39], s63 offen sc1
    buffer_store_dwordx4 v[160:163], v128, s[36:39], s63 offen sc1
    s_mov_b32 s89, 0x80000000
    s_waitcnt vmcnt(2)
    s_mov_b32 s59, 0x3f803f80
    v_mov_b32 v56, 0
    v_mov_b32 v57, 0
    v_dot2_f32_bf16 v56, v232, s59, v56
    v_dot2_f32_bf16 v57, v232, v232, v57
    v_dot2_f32_bf16 v56, v233, s59, v56
    v_dot2_f32_bf16 v57, v233, v233, v57
    v_dot2_f32_bf16 v56, v234, s59, v56
    v_dot2_f32_bf16 v57, v234, v234, v57
    v_dot2_f32_bf16 v56, v235, s59, v56
    v_dot2_f32_bf16 v57, v235, v235, v57
    v_dot2_f32_bf16 v56, v236, s59, v56
    v_dot2_f32_bf16 v57, v236, v236, v57
    v_dot2_f32_bf16 v56, v237, s59, v56
    v_dot2_f32_bf16 v57, v237, v237, v57
    v_dot2_f32_bf16 v56, v238, s59, v56
    v_dot2_f32_bf16 v57, v238, v238, v57
    v_dot2_f32_bf16 v56, v239, s59, v56
    v_dot2_f32_bf16 v57, v239, v239, v57
    v_dot2_f32_bf16 v56, v240, s59, v56
    v_dot2_f32_bf16 v57, v240, v240, v57
    v_dot2_f32_bf16 v56, v241, s59, v56
    v_dot2_f32_bf16 v57, v241, v241, v57
    v_dot2_f32_bf16 v56, v242, s59, v56
    v_dot2_f32_bf16 v57, v242, v242, v57
    v_dot2_f32_bf16 v56, v243, s59, v56
    v_dot2_f32_bf16 v57, v243, v243, v57
    v_dot2_f32_bf16 v56, v244, s59, v56
    v_dot2_f32_bf16 v57, v244, v244, v57
    v_dot2_f32_bf16 v56, v245, s59, v56
    v_dot2_f32_bf16 v57, v245, v245, v57
    v_dot2_f32_bf16 v56, v246, s59, v56
    v_dot2_f32_bf16 v57, v246, v246, v57
    v_dot2_f32_bf16 v56, v247, s59, v56
    v_dot2_f32_bf16 v57, v247, v247, v57
    v_dot2_f32_bf16 v56, v248, s59, v56
    v_dot2_f32_bf16 v57, v248, v248, v57
    v_dot2_f32_bf16 v56, v249, s59, v56
    v_dot2_f32_bf16 v57, v249, v249, v57
    v_dot2_f32_bf16 v56, v250, s59, v56
    v_dot2_f32_bf16 v57, v250, v250, v57
    v_dot2_f32_bf16 v56, v251, s59, v56
    v_dot2_f32_bf16 v57, v251, v251, v57
    s_nop 2
    v_add_f32_dpp v56, v56, v56 quad_perm:[1,0,3,2] row_mask:0xf bank_mask:0xf
    v_add_f32_dpp v57, v57, v57 quad_perm:[1,0,3,2] row_mask:0xf bank_mask:0xf
    s_nop 0
    v_add_f32_dpp v56, v56, v56 quad_perm:[2,3,0,1] row_mask:0xf bank_mask:0xf
    v_add_f32_dpp v57, v57, v57 quad_perm:[2,3,0,1] row_mask:0xf bank_mask:0xf
    s_nop 0
    v_add_f32_dpp v56, v56, v56 row_half_mirror row_mask:0xf bank_mask:0xf
    v_add_f32_dpp v57, v57, v57 row_half_mirror row_mask:0xf bank_mask:0xf
    s_nop 0
    v_add_f32_dpp v56, v56, v56 row_mirror row_mask:0xf bank_mask:0xf
    v_add_f32_dpp v57, v57, v57 row_mirror row_mask:0xf bank_mask:0xf
    s_nop 0
    s_mov_b32 s59, 0x3acccccd
    v_mul_f32 v56, s59, v56
    v_mul_f32 v57, s59, v57
    v_fma_f32 v57, -v56, v56, v57
    v_max_f32 v57, 0, v57
    v_cvt_pk_bf16_f32 v58, v56, v57
    v_lshlrev_b32 v60, 16, v58
    v_and_b32 v57, 0xffff0000, v58
    v_add_f32 v57, 0x3727c5ac, v57
    v_cvt_pk_bf16_f32 v57, v57, v57
    v_and_b32 v57, 0xffff0000, v57
    v_sqrt_f32 v57, v57
    s_nop 0
    v_cvt_pk_bf16_f32 v57, v57, v57
    v_and_b32 v57, 0xffff0000, v57
    v_rcp_f32 v61, v57
    v_mov_b32 v62, s48
    v_mov_b32 v63, s49
    s_lshl_b32 s60, s96, 4
    s_add_u32 s60, s60, 98304
    v_and_b32 v58, 48, v1
    s_mov_b32 exec_lo, 0x10001
    s_mov_b32 exec_hi, 0x10001
    buffer_store_dwordx4 v[60:63], v58, s[36:39], s60 offen sc1
    s_mov_b64 exec, -1
    s_mul_i32 s60, s57, 276480
    s_mul_i32 s61, s97, 138240
    s_add_u32 s60, s60, s61
    s_add_u32 s60, s60, 6291456
    s_add_u32 s28, s36, s60
    s_addc_u32 s29, s37, 0
    s_mov_b32 s30, 138240
    s_mov_b32 s31, 0x20000
    s_mul_i32 s61, s97, 110592
    s_add_u32 s61, s61, 8519680
    s_mul_i32 s60, s56, 221184
    s_add_u32 s60, s60, s61
    s_add_u32 s12, s36, s60
    s_addc_u32 s13, s37, 0
    s_mov_b32 s14, 110592
    s_mov_b32 s15, 0x20000
    s_xor_b32 s60, s56, 1
    s_mul_i32 s60, s60, 221184
    s_add_u32 s60, s60, s61
    s_add_u32 s40, s36, s60
    s_addc_u32 s41, s37, 0
    s_mov_b32 s42, 110592
    s_mov_b32 s43, 0x20000
    s_mul_i32 s16, s52, 28672
    s_mul_i32 s23, s52, 35840
    s_add_u32 s17, s16, 4096
    s_add_u32 s18, s16, 8192
    s_add_u32 s19, s16, 12288
    s_add_u32 s20, s16, 16384
    s_add_u32 s21, s16, 20480
    s_add_u32 s22, s16, 24576
    s_barrier
    ds_read_b64_tr_b16 v[144:145], v36 offset:0
    ds_read_b64_tr_b16 v[146:147], v36 offset:1024
    ds_read_b128 v[128:131], v32 offset:0
    ds_read_b128 v[132:135], v32 offset:2048
    ds_read_b128 v[136:139], v32 offset:4096
    ds_read_b128 v[140:143], v32 offset:6144
    ds_read_b64_tr_b16 v[148:149], v37 offset:0
    ds_read_b64_tr_b16 v[150:151], v37 offset:1024
    ds_read_b64_tr_b16 v[152:153], v38 offset:0
    ds_read_b64_tr_b16 v[154:155], v38 offset:1024
    ds_read_b64_tr_b16 v[156:157], v39 offset:0
    ds_read_b64_tr_b16 v[158:159], v39 offset:1024
    s_waitcnt lgkmcnt(0)
    v_mfma_f32_16x16x32_bf16 v[64:67], v[144:147], v[128:131], 0
    ds_read_b64_tr_b16 v[176:177], v36 offset:8192
    v_mfma_f32_16x16x32_bf16 v[68:71], v[144:147], v[132:135], 0
    ds_read_b64_tr_b16 v[178:179], v36 offset:9216
    v_mfma_f32_16x16x32_bf16 v[72:75], v[144:147], v[136:139], 0
    ds_read_b128 v[160:163], v33 offset:0
    v_mfma_f32_16x16x32_bf16 v[76:79], v[144:147], v[140:143], 0
    ds_read_b128 v[164:167], v33 offset:2048
    v_mfma_f32_16x16x32_bf16 v[80:83], v[148:151], v[128:131], 0
    ds_read_b128 v[168:171], v33 offset:4096
    v_mfma_f32_16x16x32_bf16 v[84:87], v[148:151], v[132:135], 0
    ds_read_b128 v[172:175], v33 offset:6144
    v_mfma_f32_16x16x32_bf16 v[88:91], v[148:151], v[136:139], 0
    ds_read_b64_tr_b16 v[180:181], v37 offset:8192
    v_mfma_f32_16x16x32_bf16 v[92:95], v[148:151], v[140:143], 0
    ds_read_b64_tr_b16 v[182:183], v37 offset:9216
    v_mfma_f32_16x16x32_bf16 v[96:99], v[152:155], v[128:131], 0
    ds_read_b64_tr_b16 v[184:185], v38 offset:8192
    v_mfma_f32_16x16x32_bf16 v[100:103], v[152:155], v[132:135], 0
    ds_read_b64_tr_b16 v[186:187], v38 offset:9216
    v_mfma_f32_16x16x32_bf16 v[104:107], v[152:155], v[136:139], 0
    ds_read_b64_tr_b16 v[188:189], v39 offset:8192
    v_mfma_f32_16x16x32_bf16 v[108:111], v[152:155], v[140:143], 0
    ds_read_b64_tr_b16 v[190:191], v39 offset:9216
    v_mfma_f32_16x16x32_bf16 v[112:115], v[156:159], v[128:131], 0
    v_mfma_f32_16x16x32_bf16 v[116:119], v[156:159], v[132:135], 0
    v_mfma_f32_16x16x32_bf16 v[120:123], v[156:159], v[136:139], 0
    v_mfma_f32_16x16x32_bf16 v[124:127], v[156:159], v[140:143], 0
    s_waitcnt lgkmcnt(0)
    s_waitcnt vmcnt(0)
    s_barrier
    s_lshl_b32 s61, s2, 7
    s_add_u32 s61, s61, 196608
    s_cmp_eq_u32 s52, 0
    s_mov_b64 exec, 1
    s_cselect_b32 s60, s88, 0x80000000
    buffer_store_dwordx2 v[24:25], v26, s[36:39], s60 offen sc1
    s_cselect_b32 s60, s61, 0x80000000
    buffer_store_dwordx2 v[24:25], v26, s[36:39], s60 offen sc1
    s_mov_b64 exec, -1
    v_mfma_f32_16x16x32_bf16 v[64:67], v[176:179], v[160:163], v[64:67]
    ds_read_b64_tr_b16 v[144:145], v36 offset:32768
    v_mfma_f32_16x16x32_bf16 v[68:71], v[176:179], v[164:167], v[68:71]
    ds_read_b64_tr_b16 v[146:147], v36 offset:33792
    v_mfma_f32_16x16x32_bf16 v[72:75], v[176:179], v[168:171], v[72:75]
    ds_read_b128 v[128:131], v32 offset:32768
    v_mfma_f32_16x16x32_bf16 v[76:79], v[176:179], v[172:175], v[76:79]
    ds_read_b128 v[132:135], v32 offset:34816
    v_mfma_f32_16x16x32_bf16 v[80:83], v[180:183], v[160:163], v[80:83]
    ds_read_b128 v[136:139], v32 offset:36864
    v_mfma_f32_16x16x32_bf16 v[84:87], v[180:183], v[164:167], v[84:87]
    ds_read_b128 v[140:143], v32 offset:38912
    v_mfma_f32_16x16x32_bf16 v[88:91], v[180:183], v[168:171], v[88:91]
    ds_read_b64_tr_b16 v[148:149], v37 offset:32768
    v_mfma_f32_16x16x32_bf16 v[92:95], v[180:183], v[172:175], v[92:95]
    ds_read_b64_tr_b16 v[150:151], v37 offset:33792
    v_mfma_f32_16x16x32_bf16 v[96:99], v[184:187], v[160:163], v[96:99]
    ds_read_b64_tr_b16 v[152:153], v38 offset:32768
    v_mfma_f32_16x16x32_bf16 v[100:103], v[184:187], v[164:167], v[100:103]
    ds_read_b64_tr_b16 v[154:155], v38 offset:33792
    v_mfma_f32_16x16x32_bf16 v[104:107], v[184:187], v[168:171], v[104:107]
    ds_read_b64_tr_b16 v[156:157], v39 offset:32768
    v_mfma_f32_16x16x32_bf16 v[108:111], v[184:187], v[172:175], v[108:111]
    ds_read_b64_tr_b16 v[158:159], v39 offset:33792
    v_mfma_f32_16x16x32_bf16 v[112:115], v[188:191], v[160:163], v[112:115]
    v_mfma_f32_16x16x32_bf16 v[116:119], v[188:191], v[164:167], v[116:119]
    v_mfma_f32_16x16x32_bf16 v[120:123], v[188:191], v[168:171], v[120:123]
    v_mfma_f32_16x16x32_bf16 v[124:127], v[188:191], v[172:175], v[124:127]
    s_waitcnt lgkmcnt(0)
    v_mfma_f32_16x16x32_bf16 v[64:67], v[144:147], v[128:131], v[64:67]
    ds_read_b64_tr_b16 v[176:177], v36 offset:40960
    v_mfma_f32_16x16x32_bf16 v[68:71], v[144:147], v[132:135], v[68:71]
    ds_read_b64_tr_b16 v[178:179], v36 offset:41984
    v_mfma_f32_16x16x32_bf16 v[72:75], v[144:147], v[136:139], v[72:75]
    ds_read_b128 v[160:163], v33 offset:32768
    v_mfma_f32_16x16x32_bf16 v[76:79], v[144:147], v[140:143], v[76:79]
    ds_read_b128 v[164:167], v33 offset:34816
    v_mfma_f32_16x16x32_bf16 v[80:83], v[148:151], v[128:131], v[80:83]
    ds_read_b128 v[168:171], v33 offset:36864
    v_mfma_f32_16x16x32_bf16 v[84:87], v[148:151], v[132:135], v[84:87]
    ds_read_b128 v[172:175], v33 offset:38912
    v_mfma_f32_16x16x32_bf16 v[88:91], v[148:151], v[136:139], v[88:91]
    ds_read_b64_tr_b16 v[180:181], v37 offset:40960
    v_mfma_f32_16x16x32_bf16 v[92:95], v[148:151], v[140:143], v[92:95]
    ds_read_b64_tr_b16 v[182:183], v37 offset:41984
    v_mfma_f32_16x16x32_bf16 v[96:99], v[152:155], v[128:131], v[96:99]
    ds_read_b64_tr_b16 v[184:185], v38 offset:40960
    v_mfma_f32_16x16x32_bf16 v[100:103], v[152:155], v[132:135], v[100:103]
    ds_read_b64_tr_b16 v[186:187], v38 offset:41984
    v_mfma_f32_16x16x32_bf16 v[104:107], v[152:155], v[136:139], v[104:107]
    ds_read_b64_tr_b16 v[188:189], v39 offset:40960
    v_mfma_f32_16x16x32_bf16 v[108:111], v[152:155], v[140:143], v[108:111]
    ds_read_b64_tr_b16 v[190:191], v39 offset:41984
    v_mfma_f32_16x16x32_bf16 v[112:115], v[156:159], v[128:131], v[112:115]
    v_mfma_f32_16x16x32_bf16 v[116:119], v[156:159], v[132:135], v[116:119]
    v_mfma_f32_16x16x32_bf16 v[120:123], v[156:159], v[136:139], v[120:123]
    v_mfma_f32_16x16x32_bf16 v[124:127], v[156:159], v[140:143], v[124:127]
    s_waitcnt lgkmcnt(0)
    s_barrier
    v_mfma_f32_16x16x32_bf16 v[64:67], v[176:179], v[160:163], v[64:67]
    ds_read_b64_tr_b16 v[144:145], v40 offset:0
    v_mfma_f32_16x16x32_bf16 v[68:71], v[176:179], v[164:167], v[68:71]
    ds_read_b64_tr_b16 v[146:147], v40 offset:1024
    v_mfma_f32_16x16x32_bf16 v[72:75], v[176:179], v[168:171], v[72:75]
    ds_read_b128 v[128:131], v34 offset:0
    v_mfma_f32_16x16x32_bf16 v[76:79], v[176:179], v[172:175], v[76:79]
    ds_read_b128 v[132:135], v34 offset:2048
    v_mfma_f32_16x16x32_bf16 v[80:83], v[180:183], v[160:163], v[80:83]
    ds_read_b128 v[136:139], v34 offset:4096
    v_mfma_f32_16x16x32_bf16 v[84:87], v[180:183], v[164:167], v[84:87]
    ds_read_b128 v[140:143], v34 offset:6144
    v_mfma_f32_16x16x32_bf16 v[88:91], v[180:183], v[168:171], v[88:91]
    ds_read_b64_tr_b16 v[148:149], v41 offset:0
    v_mfma_f32_16x16x32_bf16 v[92:95], v[180:183], v[172:175], v[92:95]
    ds_read_b64_tr_b16 v[150:151], v41 offset:1024
    v_mfma_f32_16x16x32_bf16 v[96:99], v[184:187], v[160:163], v[96:99]
    ds_read_b64_tr_b16 v[152:153], v42 offset:0
    v_mfma_f32_16x16x32_bf16 v[100:103], v[184:187], v[164:167], v[100:103]
    ds_read_b64_tr_b16 v[154:155], v42 offset:1024
    v_mfma_f32_16x16x32_bf16 v[104:107], v[184:187], v[168:171], v[104:107]
    ds_read_b64_tr_b16 v[156:157], v43 offset:0
    v_mfma_f32_16x16x32_bf16 v[108:111], v[184:187], v[172:175], v[108:111]
    ds_read_b64_tr_b16 v[158:159], v43 offset:1024
    v_mfma_f32_16x16x32_bf16 v[112:115], v[188:191], v[160:163], v[112:115]
    v_mfma_f32_16x16x32_bf16 v[116:119], v[188:191], v[164:167], v[116:119]
    v_mfma_f32_16x16x32_bf16 v[120:123], v[188:191], v[168:171], v[120:123]
    v_mfma_f32_16x16x32_bf16 v[124:127], v[188:191], v[172:175], v[124:127]
    s_waitcnt lgkmcnt(0)
    v_mfma_f32_16x16x32_bf16 v[64:67], v[144:147], v[128:131], v[64:67]
    ds_read_b64_tr_b16 v[176:177], v40 offset:8192
    v_mfma_f32_16x16x32_bf16 v[68:71], v[144:147], v[132:135], v[68:71]
    ds_read_b64_tr_b16 v[178:179], v40 offset:9216
    v_mfma_f32_16x16x32_bf16 v[72:75], v[144:147], v[136:139], v[72:75]
    ds_read_b128 v[160:163], v35 offset:0
    v_mfma_f32_16x16x32_bf16 v[76:79], v[144:147], v[140:143], v[76:79]
    ds_read_b128 v[164:167], v35 offset:2048
    v_mfma_f32_16x16x32_bf16 v[80:83], v[148:151], v[128:131], v[80:83]
    ds_read_b128 v[168:171], v35 offset:4096
    v_mfma_f32_16x16x32_bf16 v[84:87], v[148:151], v[132:135], v[84:87]
    ds_read_b128 v[172:175], v35 offset:6144
    v_mfma_f32_16x16x32_bf16 v[88:91], v[148:151], v[136:139], v[88:91]
    ds_read_b64_tr_b16 v[180:181], v41 offset:8192
    v_mfma_f32_16x16x32_bf16 v[92:95], v[148:151], v[140:143], v[92:95]
    ds_read_b64_tr_b16 v[182:183], v41 offset:9216
    v_mfma_f32_16x16x32_bf16 v[96:99], v[152:155], v[128:131], v[96:99]
    ds_read_b64_tr_b16 v[184:185], v42 offset:8192
    v_mfma_f32_16x16x32_bf16 v[100:103], v[152:155], v[132:135], v[100:103]
    ds_read_b64_tr_b16 v[186:187], v42 offset:9216
    v_mfma_f32_16x16x32_bf16 v[104:107], v[152:155], v[136:139], v[104:107]
    ds_read_b64_tr_b16 v[188:189], v43 offset:8192
    v_mfma_f32_16x16x32_bf16 v[108:111], v[152:155], v[140:143], v[108:111]
    ds_read_b64_tr_b16 v[190:191], v43 offset:9216
    v_mfma_f32_16x16x32_bf16 v[112:115], v[156:159], v[128:131], v[112:115]
    v_mfma_f32_16x16x32_bf16 v[116:119], v[156:159], v[132:135], v[116:119]
    v_mfma_f32_16x16x32_bf16 v[120:123], v[156:159], v[136:139], v[120:123]
    v_mfma_f32_16x16x32_bf16 v[124:127], v[156:159], v[140:143], v[124:127]
    s_waitcnt lgkmcnt(0)
    s_barrier
    v_mfma_f32_16x16x32_bf16 v[64:67], v[176:179], v[160:163], v[64:67]
    ds_read_b64_tr_b16 v[144:145], v40 offset:32768
    v_mfma_f32_16x16x32_bf16 v[68:71], v[176:179], v[164:167], v[68:71]
    ds_read_b64_tr_b16 v[146:147], v40 offset:33792
    v_mfma_f32_16x16x32_bf16 v[72:75], v[176:179], v[168:171], v[72:75]
    ds_read_b128 v[128:131], v34 offset:32768
    v_mfma_f32_16x16x32_bf16 v[76:79], v[176:179], v[172:175], v[76:79]
    ds_read_b128 v[132:135], v34 offset:34816
    v_mfma_f32_16x16x32_bf16 v[80:83], v[180:183], v[160:163], v[80:83]
    ds_read_b128 v[136:139], v34 offset:36864
    v_mfma_f32_16x16x32_bf16 v[84:87], v[180:183], v[164:167], v[84:87]
    ds_read_b128 v[140:143], v34 offset:38912
    v_mfma_f32_16x16x32_bf16 v[88:91], v[180:183], v[168:171], v[88:91]
    ds_read_b64_tr_b16 v[148:149], v41 offset:32768
    v_mfma_f32_16x16x32_bf16 v[92:95], v[180:183], v[172:175], v[92:95]
    ds_read_b64_tr_b16 v[150:151], v41 offset:33792
    v_mfma_f32_16x16x32_bf16 v[96:99], v[184:187], v[160:163], v[96:99]
    ds_read_b64_tr_b16 v[152:153], v42 offset:32768
    v_mfma_f32_16x16x32_bf16 v[100:103], v[184:187], v[164:167], v[100:103]
    ds_read_b64_tr_b16 v[154:155], v42 offset:33792
    v_mfma_f32_16x16x32_bf16 v[104:107], v[184:187], v[168:171], v[104:107]
    ds_read_b64_tr_b16 v[156:157], v43 offset:32768
    v_mfma_f32_16x16x32_bf16 v[108:111], v[184:187], v[172:175], v[108:111]
    ds_read_b64_tr_b16 v[158:159], v43 offset:33792
    v_mfma_f32_16x16x32_bf16 v[112:115], v[188:191], v[160:163], v[112:115]
    v_mfma_f32_16x16x32_bf16 v[116:119], v[188:191], v[164:167], v[116:119]
    v_mfma_f32_16x16x32_bf16 v[120:123], v[188:191], v[168:171], v[120:123]
    v_mfma_f32_16x16x32_bf16 v[124:127], v[188:191], v[172:175], v[124:127]
    s_waitcnt lgkmcnt(0)
    v_mfma_f32_16x16x32_bf16 v[64:67], v[144:147], v[128:131], v[64:67]
    ds_read_b64_tr_b16 v[176:177], v40 offset:40960
    v_mfma_f32_16x16x32_bf16 v[68:71], v[144:147], v[132:135], v[68:71]
    ds_read_b64_tr_b16 v[178:179], v40 offset:41984
    v_mfma_f32_16x16x32_bf16 v[72:75], v[144:147], v[136:139], v[72:75]
    ds_read_b128 v[160:163], v35 offset:32768
    v_mfma_f32_16x16x32_bf16 v[76:79], v[144:147], v[140:143], v[76:79]
    ds_read_b128 v[164:167], v35 offset:34816
    v_mfma_f32_16x16x32_bf16 v[80:83], v[148:151], v[128:131], v[80:83]
    ds_read_b128 v[168:171], v35 offset:36864
    v_mfma_f32_16x16x32_bf16 v[84:87], v[148:151], v[132:135], v[84:87]
    ds_read_b128 v[172:175], v35 offset:38912
    v_mfma_f32_16x16x32_bf16 v[88:91], v[148:151], v[136:139], v[88:91]
    ds_read_b64_tr_b16 v[180:181], v41 offset:40960
    v_mfma_f32_16x16x32_bf16 v[92:95], v[148:151], v[140:143], v[92:95]
    ds_read_b64_tr_b16 v[182:183], v41 offset:41984
    v_mfma_f32_16x16x32_bf16 v[96:99], v[152:155], v[128:131], v[96:99]
    ds_read_b64_tr_b16 v[184:185], v42 offset:40960
    v_mfma_f32_16x16x32_bf16 v[100:103], v[152:155], v[132:135], v[100:103]
    ds_read_b64_tr_b16 v[186:187], v42 offset:41984
    v_mfma_f32_16x16x32_bf16 v[104:107], v[152:155], v[136:139], v[104:107]
    ds_read_b64_tr_b16 v[188:189], v43 offset:40960
    v_mfma_f32_16x16x32_bf16 v[108:111], v[152:155], v[140:143], v[108:111]
    ds_read_b64_tr_b16 v[190:191], v43 offset:41984
    v_mfma_f32_16x16x32_bf16 v[112:115], v[156:159], v[128:131], v[112:115]
    v_mfma_f32_16x16x32_bf16 v[116:119], v[156:159], v[132:135], v[116:119]
    v_mfma_f32_16x16x32_bf16 v[120:123], v[156:159], v[136:139], v[120:123]
    v_mfma_f32_16x16x32_bf16 v[124:127], v[156:159], v[140:143], v[124:127]
    s_waitcnt lgkmcnt(0)
    s_barrier
    v_mfma_f32_16x16x32_bf16 v[64:67], v[176:179], v[160:163], v[64:67]
    ds_read_b64_tr_b16 v[144:145], v36 offset:0
    v_mfma_f32_16x16x32_bf16 v[68:71], v[176:179], v[164:167], v[68:71]
    ds_read_b64_tr_b16 v[146:147], v36 offset:1024
    v_mfma_f32_16x16x32_bf16 v[72:75], v[176:179], v[168:171], v[72:75]
    ds_read_b128 v[128:131], v32 offset:0
    v_mfma_f32_16x16x32_bf16 v[76:79], v[176:179], v[172:175], v[76:79]
    ds_read_b128 v[132:135], v32 offset:2048
    v_mfma_f32_16x16x32_bf16 v[80:83], v[180:183], v[160:163], v[80:83]
    ds_read_b128 v[136:139], v32 offset:4096
    v_mfma_f32_16x16x32_bf16 v[84:87], v[180:183], v[164:167], v[84:87]
    ds_read_b128 v[140:143], v32 offset:6144
    v_mfma_f32_16x16x32_bf16 v[88:91], v[180:183], v[168:171], v[88:91]
    ds_read_b64_tr_b16 v[148:149], v37 offset:0
    v_mfma_f32_16x16x32_bf16 v[92:95], v[180:183], v[172:175], v[92:95]
    ds_read_b64_tr_b16 v[150:151], v37 offset:1024
    v_mfma_f32_16x16x32_bf16 v[96:99], v[184:187], v[160:163], v[96:99]
    ds_read_b64_tr_b16 v[152:153], v38 offset:0
    v_mfma_f32_16x16x32_bf16 v[100:103], v[184:187], v[164:167], v[100:103]
    ds_read_b64_tr_b16 v[154:155], v38 offset:1024
    v_mfma_f32_16x16x32_bf16 v[104:107], v[184:187], v[168:171], v[104:107]
    ds_read_b64_tr_b16 v[156:157], v39 offset:0
    v_mfma_f32_16x16x32_bf16 v[108:111], v[184:187], v[172:175], v[108:111]
    ds_read_b64_tr_b16 v[158:159], v39 offset:1024
    v_mfma_f32_16x16x32_bf16 v[112:115], v[188:191], v[160:163], v[112:115]
    v_mfma_f32_16x16x32_bf16 v[116:119], v[188:191], v[164:167], v[116:119]
    v_mfma_f32_16x16x32_bf16 v[120:123], v[188:191], v[168:171], v[120:123]
    v_mfma_f32_16x16x32_bf16 v[124:127], v[188:191], v[172:175], v[124:127]
    s_waitcnt lgkmcnt(0)
    v_mfma_f32_16x16x32_bf16 v[64:67], v[144:147], v[128:131], v[64:67]
    ds_read_b64_tr_b16 v[176:177], v36 offset:8192
    v_mfma_f32_16x16x32_bf16 v[68:71], v[144:147], v[132:135], v[68:71]
    ds_read_b64_tr_b16 v[178:179], v36 offset:9216
    v_mfma_f32_16x16x32_bf16 v[72:75], v[144:147], v[136:139], v[72:75]
    ds_read_b128 v[160:163], v33 offset:0
    v_mfma_f32_16x16x32_bf16 v[76:79], v[144:147], v[140:143], v[76:79]
    ds_read_b128 v[164:167], v33 offset:2048
    v_mfma_f32_16x16x32_bf16 v[80:83], v[148:151], v[128:131], v[80:83]
    ds_read_b128 v[168:171], v33 offset:4096
    v_mfma_f32_16x16x32_bf16 v[84:87], v[148:151], v[132:135], v[84:87]
    ds_read_b128 v[172:175], v33 offset:6144
    v_mfma_f32_16x16x32_bf16 v[88:91], v[148:151], v[136:139], v[88:91]
    ds_read_b64_tr_b16 v[180:181], v37 offset:8192
    v_mfma_f32_16x16x32_bf16 v[92:95], v[148:151], v[140:143], v[92:95]
    ds_read_b64_tr_b16 v[182:183], v37 offset:9216
    v_mfma_f32_16x16x32_bf16 v[96:99], v[152:155], v[128:131], v[96:99]
    ds_read_b64_tr_b16 v[184:185], v38 offset:8192
    v_mfma_f32_16x16x32_bf16 v[100:103], v[152:155], v[132:135], v[100:103]
    ds_read_b64_tr_b16 v[186:187], v38 offset:9216
    v_mfma_f32_16x16x32_bf16 v[104:107], v[152:155], v[136:139], v[104:107]
    ds_read_b64_tr_b16 v[188:189], v39 offset:8192
    v_mfma_f32_16x16x32_bf16 v[108:111], v[152:155], v[140:143], v[108:111]
    ds_read_b64_tr_b16 v[190:191], v39 offset:9216
    v_mfma_f32_16x16x32_bf16 v[112:115], v[156:159], v[128:131], v[112:115]
    v_mfma_f32_16x16x32_bf16 v[116:119], v[156:159], v[132:135], v[116:119]
    v_mfma_f32_16x16x32_bf16 v[120:123], v[156:159], v[136:139], v[120:123]
    v_mfma_f32_16x16x32_bf16 v[124:127], v[156:159], v[140:143], v[124:127]
    s_waitcnt lgkmcnt(0)
    s_barrier
    v_mfma_f32_16x16x32_bf16 v[64:67], v[176:179], v[160:163], v[64:67]
    ds_read_b64_tr_b16 v[144:145], v36 offset:32768
    v_mfma_f32_16x16x32_bf16 v[68:71], v[176:179], v[164:167], v[68:71]
    ds_read_b64_tr_b16 v[146:147], v36 offset:33792
    v_mfma_f32_16x16x32_bf16 v[72:75], v[176:179], v[168:171], v[72:75]
    ds_read_b128 v[128:131], v32 offset:32768
    v_mfma_f32_16x16x32_bf16 v[76:79], v[176:179], v[172:175], v[76:79]
    ds_read_b128 v[132:135], v32 offset:34816
    v_mfma_f32_16x16x32_bf16 v[80:83], v[180:183], v[160:163], v[80:83]
    ds_read_b128 v[136:139], v32 offset:36864
    v_mfma_f32_16x16x32_bf16 v[84:87], v[180:183], v[164:167], v[84:87]
    ds_read_b128 v[140:143], v32 offset:38912
    v_mfma_f32_16x16x32_bf16 v[88:91], v[180:183], v[168:171], v[88:91]
    ds_read_b64_tr_b16 v[148:149], v37 offset:32768
    v_mfma_f32_16x16x32_bf16 v[92:95], v[180:183], v[172:175], v[92:95]
    ds_read_b64_tr_b16 v[150:151], v37 offset:33792
    v_mfma_f32_16x16x32_bf16 v[96:99], v[184:187], v[160:163], v[96:99]
    ds_read_b64_tr_b16 v[152:153], v38 offset:32768
    v_mfma_f32_16x16x32_bf16 v[100:103], v[184:187], v[164:167], v[100:103]
    ds_read_b64_tr_b16 v[154:155], v38 offset:33792
    v_mfma_f32_16x16x32_bf16 v[104:107], v[184:187], v[168:171], v[104:107]
    ds_read_b64_tr_b16 v[156:157], v39 offset:32768
    v_mfma_f32_16x16x32_bf16 v[108:111], v[184:187], v[172:175], v[108:111]
    ds_read_b64_tr_b16 v[158:159], v39 offset:33792
    v_mfma_f32_16x16x32_bf16 v[112:115], v[188:191], v[160:163], v[112:115]
    v_mfma_f32_16x16x32_bf16 v[116:119], v[188:191], v[164:167], v[116:119]
    v_mfma_f32_16x16x32_bf16 v[120:123], v[188:191], v[168:171], v[120:123]
    v_mfma_f32_16x16x32_bf16 v[124:127], v[188:191], v[172:175], v[124:127]
    s_waitcnt lgkmcnt(0)
    v_mfma_f32_16x16x32_bf16 v[64:67], v[144:147], v[128:131], v[64:67]
    ds_read_b64_tr_b16 v[176:177], v36 offset:40960
    v_mfma_f32_16x16x32_bf16 v[68:71], v[144:147], v[132:135], v[68:71]
    ds_read_b64_tr_b16 v[178:179], v36 offset:41984
    v_mfma_f32_16x16x32_bf16 v[72:75], v[144:147], v[136:139], v[72:75]
    ds_read_b128 v[160:163], v33 offset:32768
    v_mfma_f32_16x16x32_bf16 v[76:79], v[144:147], v[140:143], v[76:79]
    ds_read_b128 v[164:167], v33 offset:34816
    v_mfma_f32_16x16x32_bf16 v[80:83], v[148:151], v[128:131], v[80:83]
    ds_read_b128 v[168:171], v33 offset:36864
    v_mfma_f32_16x16x32_bf16 v[84:87], v[148:151], v[132:135], v[84:87]
    ds_read_b128 v[172:175], v33 offset:38912
    v_mfma_f32_16x16x32_bf16 v[88:91], v[148:151], v[136:139], v[88:91]
    ds_read_b64_tr_b16 v[180:181], v37 offset:40960
    v_mfma_f32_16x16x32_bf16 v[92:95], v[148:151], v[140:143], v[92:95]
    ds_read_b64_tr_b16 v[182:183], v37 offset:41984
    v_mfma_f32_16x16x32_bf16 v[96:99], v[152:155], v[128:131], v[96:99]
    ds_read_b64_tr_b16 v[184:185], v38 offset:40960
    v_mfma_f32_16x16x32_bf16 v[100:103], v[152:155], v[132:135], v[100:103]
    ds_read_b64_tr_b16 v[186:187], v38 offset:41984
    v_mfma_f32_16x16x32_bf16 v[104:107], v[152:155], v[136:139], v[104:107]
    ds_read_b64_tr_b16 v[188:189], v39 offset:40960
    v_mfma_f32_16x16x32_bf16 v[108:111], v[152:155], v[140:143], v[108:111]
    ds_read_b64_tr_b16 v[190:191], v39 offset:41984
    v_mfma_f32_16x16x32_bf16 v[112:115], v[156:159], v[128:131], v[112:115]
    v_mfma_f32_16x16x32_bf16 v[116:119], v[156:159], v[132:135], v[116:119]
    v_mfma_f32_16x16x32_bf16 v[120:123], v[156:159], v[136:139], v[120:123]
    v_mfma_f32_16x16x32_bf16 v[124:127], v[156:159], v[140:143], v[124:127]
    s_waitcnt lgkmcnt(0)
    s_barrier
    v_mfma_f32_16x16x32_bf16 v[64:67], v[176:179], v[160:163], v[64:67]
    ds_read_b64_tr_b16 v[144:145], v40 offset:0
    v_mfma_f32_16x16x32_bf16 v[68:71], v[176:179], v[164:167], v[68:71]
    ds_read_b64_tr_b16 v[146:147], v40 offset:1024
    v_mfma_f32_16x16x32_bf16 v[72:75], v[176:179], v[168:171], v[72:75]
    ds_read_b128 v[128:131], v34 offset:0
    v_mfma_f32_16x16x32_bf16 v[76:79], v[176:179], v[172:175], v[76:79]
    ds_read_b128 v[132:135], v34 offset:2048
    v_mfma_f32_16x16x32_bf16 v[80:83], v[180:183], v[160:163], v[80:83]
    ds_read_b128 v[136:139], v34 offset:4096
    v_mfma_f32_16x16x32_bf16 v[84:87], v[180:183], v[164:167], v[84:87]
    ds_read_b128 v[140:143], v34 offset:6144
    v_mfma_f32_16x16x32_bf16 v[88:91], v[180:183], v[168:171], v[88:91]
    ds_read_b64_tr_b16 v[148:149], v41 offset:0
    v_mfma_f32_16x16x32_bf16 v[92:95], v[180:183], v[172:175], v[92:95]
    ds_read_b64_tr_b16 v[150:151], v41 offset:1024
    v_mfma_f32_16x16x32_bf16 v[96:99], v[184:187], v[160:163], v[96:99]
    ds_read_b64_tr_b16 v[152:153], v42 offset:0
    v_mfma_f32_16x16x32_bf16 v[100:103], v[184:187], v[164:167], v[100:103]
    ds_read_b64_tr_b16 v[154:155], v42 offset:1024
    v_mfma_f32_16x16x32_bf16 v[104:107], v[184:187], v[168:171], v[104:107]
    ds_read_b64_tr_b16 v[156:157], v43 offset:0
    v_mfma_f32_16x16x32_bf16 v[108:111], v[184:187], v[172:175], v[108:111]
    ds_read_b64_tr_b16 v[158:159], v43 offset:1024
    v_mfma_f32_16x16x32_bf16 v[112:115], v[188:191], v[160:163], v[112:115]
    v_mfma_f32_16x16x32_bf16 v[116:119], v[188:191], v[164:167], v[116:119]
    v_mfma_f32_16x16x32_bf16 v[120:123], v[188:191], v[168:171], v[120:123]
    v_mfma_f32_16x16x32_bf16 v[124:127], v[188:191], v[172:175], v[124:127]
    s_waitcnt lgkmcnt(0)
    v_mfma_f32_16x16x32_bf16 v[64:67], v[144:147], v[128:131], v[64:67]
    ds_read_b64_tr_b16 v[176:177], v40 offset:8192
    v_mfma_f32_16x16x32_bf16 v[68:71], v[144:147], v[132:135], v[68:71]
    ds_read_b64_tr_b16 v[178:179], v40 offset:9216
    v_mfma_f32_16x16x32_bf16 v[72:75], v[144:147], v[136:139], v[72:75]
    ds_read_b128 v[160:163], v35 offset:0
    v_mfma_f32_16x16x32_bf16 v[76:79], v[144:147], v[140:143], v[76:79]
    ds_read_b128 v[164:167], v35 offset:2048
    v_mfma_f32_16x16x32_bf16 v[80:83], v[148:151], v[128:131], v[80:83]
    ds_read_b128 v[168:171], v35 offset:4096
    v_mfma_f32_16x16x32_bf16 v[84:87], v[148:151], v[132:135], v[84:87]
    ds_read_b128 v[172:175], v35 offset:6144
    v_mfma_f32_16x16x32_bf16 v[88:91], v[148:151], v[136:139], v[88:91]
    ds_read_b64_tr_b16 v[180:181], v41 offset:8192
    v_mfma_f32_16x16x32_bf16 v[92:95], v[148:151], v[140:143], v[92:95]
    ds_read_b64_tr_b16 v[182:183], v41 offset:9216
    v_mfma_f32_16x16x32_bf16 v[96:99], v[152:155], v[128:131], v[96:99]
    ds_read_b64_tr_b16 v[184:185], v42 offset:8192
    v_mfma_f32_16x16x32_bf16 v[100:103], v[152:155], v[132:135], v[100:103]
    ds_read_b64_tr_b16 v[186:187], v42 offset:9216
    v_mfma_f32_16x16x32_bf16 v[104:107], v[152:155], v[136:139], v[104:107]
    ds_read_b64_tr_b16 v[188:189], v43 offset:8192
    v_mfma_f32_16x16x32_bf16 v[108:111], v[152:155], v[140:143], v[108:111]
    ds_read_b64_tr_b16 v[190:191], v43 offset:9216
    v_mfma_f32_16x16x32_bf16 v[112:115], v[156:159], v[128:131], v[112:115]
    v_mfma_f32_16x16x32_bf16 v[116:119], v[156:159], v[132:135], v[116:119]
    v_mfma_f32_16x16x32_bf16 v[120:123], v[156:159], v[136:139], v[120:123]
    v_mfma_f32_16x16x32_bf16 v[124:127], v[156:159], v[140:143], v[124:127]
    s_waitcnt lgkmcnt(0)
    s_barrier
    v_mfma_f32_16x16x32_bf16 v[64:67], v[176:179], v[160:163], v[64:67]
    ds_read_b64_tr_b16 v[144:145], v40 offset:32768
    v_mfma_f32_16x16x32_bf16 v[68:71], v[176:179], v[164:167], v[68:71]
    ds_read_b64_tr_b16 v[146:147], v40 offset:33792
    v_mfma_f32_16x16x32_bf16 v[72:75], v[176:179], v[168:171], v[72:75]
    ds_read_b128 v[128:131], v34 offset:32768
    v_mfma_f32_16x16x32_bf16 v[76:79], v[176:179], v[172:175], v[76:79]
    ds_read_b128 v[132:135], v34 offset:34816
    v_mfma_f32_16x16x32_bf16 v[80:83], v[180:183], v[160:163], v[80:83]
    ds_read_b128 v[136:139], v34 offset:36864
    v_mfma_f32_16x16x32_bf16 v[84:87], v[180:183], v[164:167], v[84:87]
    ds_read_b128 v[140:143], v34 offset:38912
    v_mfma_f32_16x16x32_bf16 v[88:91], v[180:183], v[168:171], v[88:91]
    ds_read_b64_tr_b16 v[148:149], v41 offset:32768
    v_mfma_f32_16x16x32_bf16 v[92:95], v[180:183], v[172:175], v[92:95]
    ds_read_b64_tr_b16 v[150:151], v41 offset:33792
    v_mfma_f32_16x16x32_bf16 v[96:99], v[184:187], v[160:163], v[96:99]
    ds_read_b64_tr_b16 v[152:153], v42 offset:32768
    v_mfma_f32_16x16x32_bf16 v[100:103], v[184:187], v[164:167], v[100:103]
    ds_read_b64_tr_b16 v[154:155], v42 offset:33792
    v_mfma_f32_16x16x32_bf16 v[104:107], v[184:187], v[168:171], v[104:107]
    ds_read_b64_tr_b16 v[156:157], v43 offset:32768
    v_mfma_f32_16x16x32_bf16 v[108:111], v[184:187], v[172:175], v[108:111]
    ds_read_b64_tr_b16 v[158:159], v43 offset:33792
    v_mfma_f32_16x16x32_bf16 v[112:115], v[188:191], v[160:163], v[112:115]
    v_mfma_f32_16x16x32_bf16 v[116:119], v[188:191], v[164:167], v[116:119]
    v_mfma_f32_16x16x32_bf16 v[120:123], v[188:191], v[168:171], v[120:123]
    v_mfma_f32_16x16x32_bf16 v[124:127], v[188:191], v[172:175], v[124:127]
    s_waitcnt lgkmcnt(0)
    v_mfma_f32_16x16x32_bf16 v[64:67], v[144:147], v[128:131], v[64:67]
    ds_read_b64_tr_b16 v[176:177], v40 offset:40960
    v_mfma_f32_16x16x32_bf16 v[68:71], v[144:147], v[132:135], v[68:71]
    ds_read_b64_tr_b16 v[178:179], v40 offset:41984
    v_mfma_f32_16x16x32_bf16 v[72:75], v[144:147], v[136:139], v[72:75]
    ds_read_b128 v[160:163], v35 offset:32768
    v_mfma_f32_16x16x32_bf16 v[76:79], v[144:147], v[140:143], v[76:79]
    ds_read_b128 v[164:167], v35 offset:34816
    v_mfma_f32_16x16x32_bf16 v[80:83], v[148:151], v[128:131], v[80:83]
    ds_read_b128 v[168:171], v35 offset:36864
    v_mfma_f32_16x16x32_bf16 v[84:87], v[148:151], v[132:135], v[84:87]
    ds_read_b128 v[172:175], v35 offset:38912
    v_mfma_f32_16x16x32_bf16 v[88:91], v[148:151], v[136:139], v[88:91]
    ds_read_b64_tr_b16 v[180:181], v41 offset:40960
    v_mfma_f32_16x16x32_bf16 v[92:95], v[148:151], v[140:143], v[92:95]
    ds_read_b64_tr_b16 v[182:183], v41 offset:41984
    v_mfma_f32_16x16x32_bf16 v[96:99], v[152:155], v[128:131], v[96:99]
    ds_read_b64_tr_b16 v[184:185], v42 offset:40960
    v_mfma_f32_16x16x32_bf16 v[100:103], v[152:155], v[132:135], v[100:103]
    ds_read_b64_tr_b16 v[186:187], v42 offset:41984
    v_mfma_f32_16x16x32_bf16 v[104:107], v[152:155], v[136:139], v[104:107]
    ds_read_b64_tr_b16 v[188:189], v43 offset:40960
    v_mfma_f32_16x16x32_bf16 v[108:111], v[152:155], v[140:143], v[108:111]
    ds_read_b64_tr_b16 v[190:191], v43 offset:41984
    v_mfma_f32_16x16x32_bf16 v[112:115], v[156:159], v[128:131], v[112:115]
    v_mfma_f32_16x16x32_bf16 v[116:119], v[156:159], v[132:135], v[116:119]
    v_mfma_f32_16x16x32_bf16 v[120:123], v[156:159], v[136:139], v[120:123]
    v_mfma_f32_16x16x32_bf16 v[124:127], v[156:159], v[140:143], v[124:127]
    s_waitcnt lgkmcnt(0)
    s_barrier
    v_mfma_f32_16x16x32_bf16 v[64:67], v[176:179], v[160:163], v[64:67]
    ds_read_b64_tr_b16 v[144:145], v36 offset:0
    v_mfma_f32_16x16x32_bf16 v[68:71], v[176:179], v[164:167], v[68:71]
    ds_read_b64_tr_b16 v[146:147], v36 offset:1024
    v_mfma_f32_16x16x32_bf16 v[72:75], v[176:179], v[168:171], v[72:75]
    ds_read_b128 v[128:131], v32 offset:0
    v_mfma_f32_16x16x32_bf16 v[76:79], v[176:179], v[172:175], v[76:79]
    ds_read_b128 v[132:135], v32 offset:2048
    v_mfma_f32_16x16x32_bf16 v[80:83], v[180:183], v[160:163], v[80:83]
    ds_read_b128 v[136:139], v32 offset:4096
    v_mfma_f32_16x16x32_bf16 v[84:87], v[180:183], v[164:167], v[84:87]
    ds_read_b128 v[140:143], v32 offset:6144
    v_mfma_f32_16x16x32_bf16 v[88:91], v[180:183], v[168:171], v[88:91]
    ds_read_b64_tr_b16 v[148:149], v37 offset:0
    v_mfma_f32_16x16x32_bf16 v[92:95], v[180:183], v[172:175], v[92:95]
    ds_read_b64_tr_b16 v[150:151], v37 offset:1024
    v_mfma_f32_16x16x32_bf16 v[96:99], v[184:187], v[160:163], v[96:99]
    ds_read_b64_tr_b16 v[152:153], v38 offset:0
    v_mfma_f32_16x16x32_bf16 v[100:103], v[184:187], v[164:167], v[100:103]
    ds_read_b64_tr_b16 v[154:155], v38 offset:1024
    v_mfma_f32_16x16x32_bf16 v[104:107], v[184:187], v[168:171], v[104:107]
    ds_read_b64_tr_b16 v[156:157], v39 offset:0
    v_mfma_f32_16x16x32_bf16 v[108:111], v[184:187], v[172:175], v[108:111]
    ds_read_b64_tr_b16 v[158:159], v39 offset:1024
    v_mfma_f32_16x16x32_bf16 v[112:115], v[188:191], v[160:163], v[112:115]
    v_mfma_f32_16x16x32_bf16 v[116:119], v[188:191], v[164:167], v[116:119]
    v_mfma_f32_16x16x32_bf16 v[120:123], v[188:191], v[168:171], v[120:123]
    v_mfma_f32_16x16x32_bf16 v[124:127], v[188:191], v[172:175], v[124:127]
    s_waitcnt lgkmcnt(0)
    v_mfma_f32_16x16x32_bf16 v[64:67], v[144:147], v[128:131], v[64:67]
    ds_read_b64_tr_b16 v[176:177], v36 offset:8192
    v_mfma_f32_16x16x32_bf16 v[68:71], v[144:147], v[132:135], v[68:71]
    ds_read_b64_tr_b16 v[178:179], v36 offset:9216
    v_mfma_f32_16x16x32_bf16 v[72:75], v[144:147], v[136:139], v[72:75]
    ds_read_b128 v[160:163], v33 offset:0
    v_mfma_f32_16x16x32_bf16 v[76:79], v[144:147], v[140:143], v[76:79]
    ds_read_b128 v[164:167], v33 offset:2048
    v_mfma_f32_16x16x32_bf16 v[80:83], v[148:151], v[128:131], v[80:83]
    ds_read_b128 v[168:171], v33 offset:4096
    v_mfma_f32_16x16x32_bf16 v[84:87], v[148:151], v[132:135], v[84:87]
    ds_read_b128 v[172:175], v33 offset:6144
    v_mfma_f32_16x16x32_bf16 v[88:91], v[148:151], v[136:139], v[88:91]
    ds_read_b64_tr_b16 v[180:181], v37 offset:8192
    v_mfma_f32_16x16x32_bf16 v[92:95], v[148:151], v[140:143], v[92:95]
    ds_read_b64_tr_b16 v[182:183], v37 offset:9216
    v_mfma_f32_16x16x32_bf16 v[96:99], v[152:155], v[128:131], v[96:99]
    ds_read_b64_tr_b16 v[184:185], v38 offset:8192
    v_mfma_f32_16x16x32_bf16 v[100:103], v[152:155], v[132:135], v[100:103]
    ds_read_b64_tr_b16 v[186:187], v38 offset:9216
    v_mfma_f32_16x16x32_bf16 v[104:107], v[152:155], v[136:139], v[104:107]
    ds_read_b64_tr_b16 v[188:189], v39 offset:8192
    v_mfma_f32_16x16x32_bf16 v[108:111], v[152:155], v[140:143], v[108:111]
    ds_read_b64_tr_b16 v[190:191], v39 offset:9216
    v_mfma_f32_16x16x32_bf16 v[112:115], v[156:159], v[128:131], v[112:115]
    v_mfma_f32_16x16x32_bf16 v[116:119], v[156:159], v[132:135], v[116:119]
    v_mfma_f32_16x16x32_bf16 v[120:123], v[156:159], v[136:139], v[120:123]
    v_mfma_f32_16x16x32_bf16 v[124:127], v[156:159], v[140:143], v[124:127]
    s_waitcnt lgkmcnt(0)
    v_mfma_f32_16x16x32_bf16 v[64:67], v[176:179], v[160:163], v[64:67]
    ds_read_b64_tr_b16 v[144:145], v36 offset:32768
    v_mfma_f32_16x16x32_bf16 v[68:71], v[176:179], v[164:167], v[68:71]
    ds_read_b64_tr_b16 v[146:147], v36 offset:33792
    v_mfma_f32_16x16x32_bf16 v[72:75], v[176:179], v[168:171], v[72:75]
    ds_read_b128 v[128:131], v32 offset:32768
    v_mfma_f32_16x16x32_bf16 v[76:79], v[176:179], v[172:175], v[76:79]
    ds_read_b128 v[132:135], v32 offset:34816
    v_mfma_f32_16x16x32_bf16 v[80:83], v[180:183], v[160:163], v[80:83]
    ds_read_b128 v[136:139], v32 offset:36864
    v_mfma_f32_16x16x32_bf16 v[84:87], v[180:183], v[164:167], v[84:87]
    ds_read_b128 v[140:143], v32 offset:38912
    v_mfma_f32_16x16x32_bf16 v[88:91], v[180:183], v[168:171], v[88:91]
    ds_read_b64_tr_b16 v[148:149], v37 offset:32768
    v_mfma_f32_16x16x32_bf16 v[92:95], v[180:183], v[172:175], v[92:95]
    ds_read_b64_tr_b16 v[150:151], v37 offset:33792
    v_mfma_f32_16x16x32_bf16 v[96:99], v[184:187], v[160:163], v[96:99]
    ds_read_b64_tr_b16 v[152:153], v38 offset:32768
    v_mfma_f32_16x16x32_bf16 v[100:103], v[184:187], v[164:167], v[100:103]
    ds_read_b64_tr_b16 v[154:155], v38 offset:33792
    v_mfma_f32_16x16x32_bf16 v[104:107], v[184:187], v[168:171], v[104:107]
    ds_read_b64_tr_b16 v[156:157], v39 offset:32768
    v_mfma_f32_16x16x32_bf16 v[108:111], v[184:187], v[172:175], v[108:111]
    ds_read_b64_tr_b16 v[158:159], v39 offset:33792
    v_mfma_f32_16x16x32_bf16 v[112:115], v[188:191], v[160:163], v[112:115]
    v_mfma_f32_16x16x32_bf16 v[116:119], v[188:191], v[164:167], v[116:119]
    v_mfma_f32_16x16x32_bf16 v[120:123], v[188:191], v[168:171], v[120:123]
    v_mfma_f32_16x16x32_bf16 v[124:127], v[188:191], v[172:175], v[124:127]
    s_waitcnt lgkmcnt(0)
    v_mfma_f32_16x16x32_bf16 v[64:67], v[144:147], v[128:131], v[64:67]
    ds_read_b64_tr_b16 v[176:177], v36 offset:40960
    v_mfma_f32_16x16x32_bf16 v[68:71], v[144:147], v[132:135], v[68:71]
    ds_read_b64_tr_b16 v[178:179], v36 offset:41984
    v_mfma_f32_16x16x32_bf16 v[72:75], v[144:147], v[136:139], v[72:75]
    ds_read_b128 v[160:163], v33 offset:32768
    v_mfma_f32_16x16x32_bf16 v[76:79], v[144:147], v[140:143], v[76:79]
    ds_read_b128 v[164:167], v33 offset:34816
    v_mfma_f32_16x16x32_bf16 v[80:83], v[148:151], v[128:131], v[80:83]
    ds_read_b128 v[168:171], v33 offset:36864
    v_mfma_f32_16x16x32_bf16 v[84:87], v[148:151], v[132:135], v[84:87]
    ds_read_b128 v[172:175], v33 offset:38912
    v_mfma_f32_16x16x32_bf16 v[88:91], v[148:151], v[136:139], v[88:91]
    ds_read_b64_tr_b16 v[180:181], v37 offset:40960
    v_mfma_f32_16x16x32_bf16 v[92:95], v[148:151], v[140:143], v[92:95]
    ds_read_b64_tr_b16 v[182:183], v37 offset:41984
    v_mfma_f32_16x16x32_bf16 v[96:99], v[152:155], v[128:131], v[96:99]
    ds_read_b64_tr_b16 v[184:185], v38 offset:40960
    v_mfma_f32_16x16x32_bf16 v[100:103], v[152:155], v[132:135], v[100:103]
    ds_read_b64_tr_b16 v[186:187], v38 offset:41984
    v_mfma_f32_16x16x32_bf16 v[104:107], v[152:155], v[136:139], v[104:107]
    ds_read_b64_tr_b16 v[188:189], v39 offset:40960
    v_mfma_f32_16x16x32_bf16 v[108:111], v[152:155], v[140:143], v[108:111]
    ds_read_b64_tr_b16 v[190:191], v39 offset:41984
    v_mfma_f32_16x16x32_bf16 v[112:115], v[156:159], v[128:131], v[112:115]
    v_mfma_f32_16x16x32_bf16 v[116:119], v[156:159], v[132:135], v[116:119]
    v_mfma_f32_16x16x32_bf16 v[120:123], v[156:159], v[136:139], v[120:123]
    v_mfma_f32_16x16x32_bf16 v[124:127], v[156:159], v[140:143], v[124:127]
    s_waitcnt lgkmcnt(0)
    v_mfma_f32_16x16x32_bf16 v[64:67], v[176:179], v[160:163], v[64:67]
    v_mfma_f32_16x16x32_bf16 v[68:71], v[176:179], v[164:167], v[68:71]
    v_mfma_f32_16x16x32_bf16 v[72:75], v[176:179], v[168:171], v[72:75]
    v_mfma_f32_16x16x32_bf16 v[76:79], v[176:179], v[172:175], v[76:79]
    v_mfma_f32_16x16x32_bf16 v[80:83], v[180:183], v[160:163], v[80:83]
    v_mfma_f32_16x16x32_bf16 v[84:87], v[180:183], v[164:167], v[84:87]
    v_mfma_f32_16x16x32_bf16 v[88:91], v[180:183], v[168:171], v[88:91]
    v_mfma_f32_16x16x32_bf16 v[92:95], v[180:183], v[172:175], v[92:95]
    v_mfma_f32_16x16x32_bf16 v[96:99], v[184:187], v[160:163], v[96:99]
    v_mfma_f32_16x16x32_bf16 v[100:103], v[184:187], v[164:167], v[100:103]
    v_and_b32 v4, 3, v1
    v_lshlrev_b32 v4, 2, v4
    v_add_u32 v4, 163792, v4
    s_mov_b32 s59, 1000000
L_lw_gran_4:
    ds_read_b32 v29, v4
    s_waitcnt lgkmcnt(0)
    v_cmp_gt_u32 vcc, 1, v29
    s_cbranch_vccz L_lwd_gran_5
    s_sleep 1
    s_sub_u32 s59, s59, 1
    s_cbranch_scc0 L_lw_gran_4
L_lwd_gran_5:
    ds_read_b32 v44, v21 offset:0
    ds_read_b32 v46, v21 offset:64
    ds_read_b32 v48, v21 offset:128
    ds_read_b32 v50, v21 offset:192
    ds_read_b128 v[128:131], v22 offset:0
    ds_read_b128 v[132:135], v22 offset:64
    ds_read_b128 v[136:139], v22 offset:128
    ds_read_b128 v[140:143], v22 offset:192
    v_mfma_f32_16x16x32_bf16 v[104:107], v[184:187], v[168:171], v[104:107]
    v_mfma_f32_16x16x32_bf16 v[108:111], v[184:187], v[172:175], v[108:111]
    v_mfma_f32_16x16x32_bf16 v[112:115], v[188:191], v[160:163], v[112:115]
    v_mfma_f32_16x16x32_bf16 v[116:119], v[188:191], v[164:167], v[116:119]
    v_mfma_f32_16x16x32_bf16 v[120:123], v[188:191], v[168:171], v[120:123]
    v_mfma_f32_16x16x32_bf16 v[124:127], v[188:191], v[172:175], v[124:127]
    s_mov_b32 s98, 0
    s_waitcnt lgkmcnt(0)
    v_pk_fma_f32 v[64:65], v[44:45], v[128:129], v[64:65] op_sel_hi:[0,1,1] neg_lo:[1,0,0] neg_hi:[1,0,0]
    v_pk_fma_f32 v[66:67], v[44:45], v[130:131], v[66:67] op_sel_hi:[0,1,1] neg_lo:[1,0,0] neg_hi:[1,0,0]
    v_pk_fma_f32 v[80:81], v[44:45], v[132:133], v[80:81] op_sel_hi:[0,1,1] neg_lo:[1,0,0] neg_hi:[1,0,0]
    v_pk_fma_f32 v[82:83], v[44:45], v[134:135], v[82:83] op_sel_hi:[0,1,1] neg_lo:[1,0,0] neg_hi:[1,0,0]
    v_cvt_pk_bf16_f32 v64, v64, v65
    v_cvt_pk_bf16_f32 v65, v66, v67
    v_cvt_pk_bf16_f32 v66, v80, v81
    v_cvt_pk_bf16_f32 v67, v82, v83
    v_pk_max_i16 v64, v64, 0
    v_pk_max_i16 v65, v65, 0
    v_pk_max_i16 v66, v66, 0
    v_pk_max_i16 v67, v67, 0
    buffer_store_dwordx4 v[64:67], v2, s[36:39], s3 offen offset:0 sc1
    v_pk_fma_f32 v[68:69], v[46:47], v[128:129], v[68:69] op_sel_hi:[0,1,1] neg_lo:[1,0,0] neg_hi:[1,0,0]
    v_pk_fma_f32 v[70:71], v[46:47], v[130:131], v[70:71] op_sel_hi:[0,1,1] neg_lo:[1,0,0] neg_hi:[1,0,0]
    v_pk_fma_f32 v[84:85], v[46:47], v[132:133], v[84:85] op_sel_hi:[0,1,1] neg_lo:[1,0,0] neg_hi:[1,0,0]
    v_pk_fma_f32 v[86:87], v[46:47], v[134:135], v[86:87] op_sel_hi:[0,1,1] neg_lo:[1,0,0] neg_hi:[1,0,0]
    v_cvt_pk_bf16_f32 v68, v68, v69
    v_cvt_pk_bf16_f32 v69, v70, v71
    v_cvt_pk_bf16_f32 v70, v84, v85
    v_cvt_pk_bf16_f32 v71, v86, v87
    v_pk_max_i16 v68, v68, 0
    v_pk_max_i16 v69, v69, 0
    v_pk_max_i16 v70, v70, 0
    v_pk_max_i16 v71, v71, 0
    buffer_store_dwordx4 v[68:71], v2, s[36:39], s3 offen offset:1024 sc1
    v_pk_fma_f32 v[72:73], v[48:49], v[128:129], v[72:73] op_sel_hi:[0,1,1] neg_lo:[1,0,0] neg_hi:[1,0,0]
    v_pk_fma_f32 v[74:75], v[48:49], v[130:131], v[74:75] op_sel_hi:[0,1,1] neg_lo:[1,0,0] neg_hi:[1,0,0]
    v_pk_fma_f32 v[88:89], v[48:49], v[132:133], v[88:89] op_sel_hi:[0,1,1] neg_lo:[1,0,0] neg_hi:[1,0,0]
    v_pk_fma_f32 v[90:91], v[48:49], v[134:135], v[90:91] op_sel_hi:[0,1,1] neg_lo:[1,0,0] neg_hi:[1,0,0]
    v_cvt_pk_bf16_f32 v72, v72, v73
    v_cvt_pk_bf16_f32 v73, v74, v75
    v_cvt_pk_bf16_f32 v74, v88, v89
    v_cvt_pk_bf16_f32 v75, v90, v91
    v_pk_max_i16 v72, v72, 0
    v_pk_max_i16 v73, v73, 0
    v_pk_max_i16 v74, v74, 0
    v_pk_max_i16 v75, v75, 0
    buffer_store_dwordx4 v[72:75], v2, s[36:39], s3 offen offset:2048 sc1
    v_pk_fma_f32 v[76:77], v[50:51], v[128:129], v[76:77] op_sel_hi:[0,1,1] neg_lo:[1,0,0] neg_hi:[1,0,0]
    v_pk_fma_f32 v[78:79], v[50:51], v[130:131], v[78:79] op_sel_hi:[0,1,1] neg_lo:[1,0,0] neg_hi:[1,0,0]
    v_pk_fma_f32 v[92:93], v[50:51], v[132:133], v[92:93] op_sel_hi:[0,1,1] neg_lo:[1,0,0] neg_hi:[1,0,0]
    v_pk_fma_f32 v[94:95], v[50:51], v[134:135], v[94:95] op_sel_hi:[0,1,1] neg_lo:[1,0,0] neg_hi:[1,0,0]
    v_cvt_pk_bf16_f32 v76, v76, v77
    v_cvt_pk_bf16_f32 v77, v78, v79
    v_cvt_pk_bf16_f32 v78, v92, v93
    v_cvt_pk_bf16_f32 v79, v94, v95
    v_pk_max_i16 v76, v76, 0
    v_pk_max_i16 v77, v77, 0
    v_pk_max_i16 v78, v78, 0
    v_pk_max_i16 v79, v79, 0
    buffer_store_dwordx4 v[76:79], v2, s[36:39], s3 offen offset:3072 sc1
    v_pk_fma_f32 v[96:97], v[44:45], v[136:137], v[96:97] op_sel_hi:[0,1,1] neg_lo:[1,0,0] neg_hi:[1,0,0]
    v_pk_fma_f32 v[98:99], v[44:45], v[138:139], v[98:99] op_sel_hi:[0,1,1] neg_lo:[1,0,0] neg_hi:[1,0,0]
    v_pk_fma_f32 v[112:113], v[44:45], v[140:141], v[112:113] op_sel_hi:[0,1,1] neg_lo:[1,0,0] neg_hi:[1,0,0]
    v_pk_fma_f32 v[114:115], v[44:45], v[142:143], v[114:115] op_sel_hi:[0,1,1] neg_lo:[1,0,0] neg_hi:[1,0,0]
    v_cvt_pk_bf16_f32 v96, v96, v97
    v_cvt_pk_bf16_f32 v97, v98, v99
    v_cvt_pk_bf16_f32 v98, v112, v113
    v_cvt_pk_bf16_f32 v99, v114, v115
    v_pk_max_i16 v96, v96, 0
    v_pk_max_i16 v97, v97, 0
    v_pk_max_i16 v98, v98, 0
    v_pk_max_i16 v99, v99, 0
    buffer_store_dwordx4 v[96:99], v3, s[36:39], s3 offen offset:0 sc1
    v_pk_fma_f32 v[100:101], v[46:47], v[136:137], v[100:101] op_sel_hi:[0,1,1] neg_lo:[1,0,0] neg_hi:[1,0,0]
    v_pk_fma_f32 v[102:103], v[46:47], v[138:139], v[102:103] op_sel_hi:[0,1,1] neg_lo:[1,0,0] neg_hi:[1,0,0]
    v_pk_fma_f32 v[116:117], v[46:47], v[140:141], v[116:117] op_sel_hi:[0,1,1] neg_lo:[1,0,0] neg_hi:[1,0,0]
    v_pk_fma_f32 v[118:119], v[46:47], v[142:143], v[118:119] op_sel_hi:[0,1,1] neg_lo:[1,0,0] neg_hi:[1,0,0]
    v_cvt_pk_bf16_f32 v100, v100, v101
    v_cvt_pk_bf16_f32 v101, v102, v103
    v_cvt_pk_bf16_f32 v102, v116, v117
    v_cvt_pk_bf16_f32 v103, v118, v119
    v_pk_max_i16 v100, v100, 0
    v_pk_max_i16 v101, v101, 0
    v_pk_max_i16 v102, v102, 0
    v_pk_max_i16 v103, v103, 0
    buffer_store_dwordx4 v[100:103], v3, s[36:39], s3 offen offset:1024 sc1
    v_pk_fma_f32 v[104:105], v[48:49], v[136:137], v[104:105] op_sel_hi:[0,1,1] neg_lo:[1,0,0] neg_hi:[1,0,0]
    v_pk_fma_f32 v[106:107], v[48:49], v[138:139], v[106:107] op_sel_hi:[0,1,1] neg_lo:[1,0,0] neg_hi:[1,0,0]
    v_pk_fma_f32 v[120:121], v[48:49], v[140:141], v[120:121] op_sel_hi:[0,1,1] neg_lo:[1,0,0] neg_hi:[1,0,0]
    v_pk_fma_f32 v[122:123], v[48:49], v[142:143], v[122:123] op_sel_hi:[0,1,1] neg_lo:[1,0,0] neg_hi:[1,0,0]
    v_cvt_pk_bf16_f32 v104, v104, v105
    v_cvt_pk_bf16_f32 v105, v106, v107
    v_cvt_pk_bf16_f32 v106, v120, v121
    v_cvt_pk_bf16_f32 v107, v122, v123
    v_pk_max_i16 v104, v104, 0
    v_pk_max_i16 v105, v105, 0
    v_pk_max_i16 v106, v106, 0
    v_pk_max_i16 v107, v107, 0
    buffer_store_dwordx4 v[104:107], v3, s[36:39], s3 offen offset:2048 sc1
    v_pk_fma_f32 v[108:109], v[50:51], v[136:137], v[108:109] op_sel_hi:[0,1,1] neg_lo:[1,0,0] neg_hi:[1,0,0]
    v_pk_fma_f32 v[110:111], v[50:51], v[138:139], v[110:111] op_sel_hi:[0,1,1] neg_lo:[1,0,0] neg_hi:[1,0,0]
    v_pk_fma_f32 v[124:125], v[50:51], v[140:141], v[124:125] op_sel_hi:[0,1,1] neg_lo:[1,0,0] neg_hi:[1,0,0]
    v_pk_fma_f32 v[126:127], v[50:51], v[142:143], v[126:127] op_sel_hi:[0,1,1] neg_lo:[1,0,0] neg_hi:[1,0,0]
    v_cvt_pk_bf16_f32 v108, v108, v109
    v_cvt_pk_bf16_f32 v109, v110, v111
    v_cvt_pk_bf16_f32 v110, v124, v125
    v_cvt_pk_bf16_f32 v111, v126, v127
    v_pk_max_i16 v108, v108, 0
    v_pk_max_i16 v109, v109, 0
    v_pk_max_i16 v110, v110, 0
    v_pk_max_i16 v111, v111, 0
    buffer_store_dwordx4 v[108:111], v3, s[36:39], s3 offen offset:3072 sc1
L_g2c:
    v_mov_b32 v30, 1
    ds_write_b32 v27, v30 offset:32
    v_mov_b32 v4, 163824
    s_mov_b32 s59, 1000000
L_lw_w2ok_6:
    ds_read_b32 v29, v4
    s_waitcnt lgkmcnt(0)
    v_cmp_gt_u32 vcc, 1, v29
    s_cbranch_vccz L_lwd_w2ok_7
    s_sleep 1
    s_sub_u32 s59, s59, 1
    s_cbranch_scc0 L_lw_w2ok_6
L_lwd_w2ok_7:
    s_add_u32 s63, s23, 0
    buffer_load_dwordx4 v[116:119], v2, s[28:31], s63 offen offset:0 sc1
    buffer_load_dwordx4 v[120:123], v2, s[28:31], s63 offen offset:1024 sc1
    buffer_load_dwordx4 v[124:127], v2, s[28:31], s63 offen offset:2048 sc1
    buffer_load_dwordx4 v[128:131], v2, s[28:31], s63 offen offset:3072 sc1
    buffer_load_dwordx4 v[132:135], v3, s[28:31], s63 offen offset:0 sc1
    s_add_u32 s63, s23, 5120
    buffer_load_dwordx4 v[136:139], v2, s[28:31], s63 offen offset:0 sc1
    buffer_load_dwordx4 v[140:143], v2, s[28:31], s63 offen offset:1024 sc1
    buffer_load_dwordx4 v[144:147], v2, s[28:31], s63 offen offset:2048 sc1
    buffer_load_dwordx4 v[148:151], v2, s[28:31], s63 offen offset:3072 sc1
    buffer_load_dwordx4 v[152:155], v3, s[28:31], s63 offen offset:0 sc1
    s_mul_i32 s60, s52, 7
    s_mul_i32 s61, s97, 27
    s_add_u32 s60, s60, s61
    s_lshr_b32 s60, s60, 1
    v_min_u32 v19, 3, v1
    v_add_u32 v19, s60, v19
    v_min_u32 v19, 26, v19
    s_xor_b32 s61, s56, 1
    s_lshl_b32 s61, s61, 5
    v_add_u32 v19, s61, v19
    v_lshlrev_b32 v19, 5, v19
    v_add_u32 v19, 262144, v19
    v_xor_b32 v18, 1024, v19
    s_mul_i32 s60, s52, 5120
    v_add_u32 v15, s60, v2
    v_add_u32 v14, 61440, v15
    v_add_u32 v10, 0, v2
    v_add_u32 v11, 1024, v2
    v_add_u32 v12, 2048, v2
    v_add_u32 v13, 3072, v2
    s_waitcnt vmcnt(10)
    s_mov_b64 exec, 1
    buffer_store_dwordx2 v[24:25], v26, s[36:39], s90 offen sc1
    s_mov_b64 exec, -1
    s_add_u32 s63, s23, 10240
    s_waitcnt vmcnt(7)
    buffer_load_dwordx4 v[156:159], v2, s[28:31], s63 offen offset:0 sc1
    s_waitcnt vmcnt(7)
    buffer_load_dwordx4 v[160:163], v2, s[28:31], s63 offen offset:1024 sc1
    s_waitcnt vmcnt(7)
    buffer_load_dwordx4 v[164:167], v2, s[28:31], s63 offen offset:2048 sc1
    s_waitcnt vmcnt(7)
    buffer_load_dwordx4 v[168:171], v2, s[28:31], s63 offen offset:3072 sc1
    s_waitcnt vmcnt(7)
    buffer_load_dwordx4 v[172:175], v3, s[28:31], s63 offen offset:0 sc1
    s_add_u32 s63, s23, 15360
    s_waitcnt vmcnt(7)
    buffer_load_dwordx4 v[176:179], v2, s[28:31], s63 offen offset:0 sc1
    s_waitcnt vmcnt(7)
    buffer_load_dwordx4 v[180:183], v2, s[28:31], s63 offen offset:1024 sc1
    s_waitcnt vmcnt(7)
    buffer_load_dwordx4 v[184:187], v2, s[28:31], s63 offen offset:2048 sc1
    s_waitcnt vmcnt(7)
    buffer_load_dwordx4 v[188:191], v2, s[28:31], s63 offen offset:3072 sc1
    s_waitcnt vmcnt(7)
    buffer_load_dwordx4 v[192:195], v3, s[28:31], s63 offen offset:0 sc1
    v_mov_b32 v8, s48
    v_mov_b32 v9, s49
    s_mov_b32 exec_lo, 15
    s_mov_b32 exec_hi, 0
    v_mov_b32 v8, 0
    v_mov_b32 v9, 0
    buffer_atomic_or_x2 v[8:9], v19, s[36:39], 0 offen sc0 sc1
    s_mov_b64 exec, -1
    s_add_u32 s63, s23, 20480
    s_waitcnt vmcnt(7)
    buffer_load_dwordx4 v[196:199], v2, s[28:31], s63 offen offset:0 sc1
    s_waitcnt vmcnt(7)
    buffer_load_dwordx4 v[200:203], v2, s[28:31], s63 offen offset:1024 sc1
    s_waitcnt vmcnt(7)
    buffer_load_dwordx4 v[204:207], v2, s[28:31], s63 offen offset:2048 sc1
    s_waitcnt vmcnt(7)
    buffer_load_dwordx4 v[208:211], v2, s[28:31], s63 offen offset:3072 sc1
    s_waitcnt vmcnt(7)
    buffer_load_dwordx4 v[212:215], v3, s[28:31], s63 offen offset:0 sc1
    s_add_u32 s63, s23, 25600
    s_waitcnt vmcnt(7)
    buffer_load_dwordx4 v[216:219], v2, s[28:31], s63 offen offset:0 sc1
    s_waitcnt vmcnt(7)
    buffer_load_dwordx4 v[220:223], v2, s[28:31], s63 offen offset:1024 sc1
    s_waitcnt vmcnt(7)
    buffer_load_dwordx4 v[224:227], v2, s[28:31], s63 offen offset:2048 sc1
    s_waitcnt vmcnt(7)
    buffer_load_dwordx4 v[228:231], v2, s[28:31], s63 offen offset:3072 sc1
    s_waitcnt vmcnt(7)
    buffer_load_dwordx4 v[232:235], v3, s[28:31], s63 offen offset:0 sc1
    s_waitcnt vmcnt(10)
    v_cmp_ne_u64 vcc, s[48:49], v[8:9]
    s_cbranch_vccz L_polld_h_9
    s_mov_b32 s59, 20000
L_poll_h_8:
    s_sleep 6
    v_mov_b32 v8, s48
    v_mov_b32 v9, s49
    s_mov_b32 exec_lo, 15
    s_mov_b32 exec_hi, 0
    v_mov_b32 v8, 0
    v_mov_b32 v9, 0
    buffer_atomic_or_x2 v[8:9], v19, s[36:39], 0 offen sc0 sc1
    s_mov_b64 exec, -1
    s_waitcnt vmcnt(0)
    v_cmp_ne_u64 vcc, s[48:49], v[8:9]
    s_cbranch_vccz L_polld_h_9
    s_sub_u32 s59, s59, 1
    s_cbranch_scc0 L_poll_h_8
L_polld_h_9:
    buffer_load_dwordx4 v[72:75], v10, s[40:43], s16 offen sc1
    buffer_load_dwordx4 v[76:79], v10, s[40:43], s17 offen sc1
    buffer_load_dwordx4 v[80:83], v10, s[40:43], s18 offen sc1
    buffer_load_dwordx4 v[84:87], v10, s[40:43], s19 offen sc1
    buffer_load_dwordx4 v[88:91], v10, s[40:43], s20 offen sc1
    buffer_load_dwordx4 v[92:95], v10, s[40:43], s21 offen sc1
    v_and_b32 v4, 3, v1
    v_lshlrev_b32 v4, 2, v4
    v_add_u32 v5, 163792, v4
    v_add_u32 v4, 163808, v4
    s_mov_b32 s59, 1000000
L_lw_call_10:
    ds_read_b32 v29, v4
    s_waitcnt lgkmcnt(0)
    v_cmp_gt_u32 vcc, 1, v29
    s_cbranch_vccz L_lwd_call_11
    s_sleep 1
    s_sub_u32 s59, s59, 1
    s_cbranch_scc0 L_lw_call_10
L_lwd_call_11:
    s_add_u32 s63, s23, 30720
    buffer_load_dwordx4 v[236:239], v2, s[28:31], s63 offen offset:0 sc1
    buffer_load_dwordx4 v[240:243], v2, s[28:31], s63 offen offset:1024 sc1
    buffer_load_dwordx4 v[244:247], v2, s[28:31], s63 offen offset:2048 sc1
    buffer_load_dwordx4 v[248:251], v2, s[28:31], s63 offen offset:3072 sc1
    buffer_load_dwordx4 v[252:255], v3, s[28:31], s63 offen offset:0 sc1
    buffer_load_dwordx4 v[96:99], v10, s[40:43], s22 offen sc1
    buffer_load_dwordx4 v[100:103], v11, s[40:43], s16 offen sc1
    buffer_load_dwordx4 v[104:107], v11, s[40:43], s17 offen sc1
    buffer_load_dwordx4 v[108:111], v11, s[40:43], s18 offen sc1
    buffer_load_dwordx4 v[112:115], v11, s[40:43], s19 offen sc1
    s_waitcnt vmcnt(15)
    v_mfma_f32_16x16x32_bf16 v[32:35], v[116:119], v[72:75], 0
    v_mfma_f32_16x16x32_bf16 v[36:39], v[120:123], v[72:75], 0
    v_mfma_f32_16x16x32_bf16 v[40:43], v[124:127], v[72:75], 0
    v_mfma_f32_16x16x32_bf16 v[44:47], v[128:131], v[72:75], 0
    v_mfma_f32_16x16x32_bf16 v[48:51], v[132:135], v[72:75], 0
    buffer_load_dwordx4 v[72:75], v11, s[40:43], s20 offen sc1
    s_waitcnt vmcnt(15)
    v_mfma_f32_16x16x32_bf16 v[32:35], v[136:139], v[76:79], v[32:35]
    v_mfma_f32_16x16x32_bf16 v[36:39], v[140:143], v[76:79], v[36:39]
    v_mfma_f32_16x16x32_bf16 v[40:43], v[144:147], v[76:79], v[40:43]
    v_mfma_f32_16x16x32_bf16 v[44:47], v[148:151], v[76:79], v[44:47]
    v_mfma_f32_16x16x32_bf16 v[48:51], v[152:155], v[76:79], v[48:51]
    buffer_load_dwordx4 v[76:79], v11, s[40:43], s21 offen sc1
    s_waitcnt vmcnt(15)
    v_mfma_f32_16x16x32_bf16 v[32:35], v[156:159], v[80:83], v[32:35]
    v_mfma_f32_16x16x32_bf16 v[36:39], v[160:163], v[80:83], v[36:39]
    v_mfma_f32_16x16x32_bf16 v[40:43], v[164:167], v[80:83], v[40:43]
    v_mfma_f32_16x16x32_bf16 v[44:47], v[168:171], v[80:83], v[44:47]
    v_mfma_f32_16x16x32_bf16 v[48:51], v[172:175], v[80:83], v[48:51]
    buffer_load_dwordx4 v[80:83], v11, s[40:43], s22 offen sc1
    s_waitcnt vmcnt(15)
    v_mfma_f32_16x16x32_bf16 v[32:35], v[176:179], v[84:87], v[32:35]
    v_mfma_f32_16x16x32_bf16 v[36:39], v[180:183], v[84:87], v[36:39]
    v_mfma_f32_16x16x32_bf16 v[40:43], v[184:187], v[84:87], v[40:43]
    v_mfma_f32_16x16x32_bf16 v[44:47], v[188:191], v[84:87], v[44:47]
    v_mfma_f32_16x16x32_bf16 v[48:51], v[192:195], v[84:87], v[48:51]
    buffer_load_dwordx4 v[84:87], v12, s[40:43], s16 offen sc1
    s_waitcnt vmcnt(15)
    v_mfma_f32_16x16x32_bf16 v[32:35], v[196:199], v[88:91], v[32:35]
    v_mfma_f32_16x16x32_bf16 v[36:39], v[200:203], v[88:91], v[36:39]
    v_mfma_f32_16x16x32_bf16 v[40:43], v[204:207], v[88:91], v[40:43]
    v_mfma_f32_16x16x32_bf16 v[44:47], v[208:211], v[88:91], v[44:47]
    v_mfma_f32_16x16x32_bf16 v[48:51], v[212:215], v[88:91], v[48:51]
    buffer_load_dwordx4 v[88:91], v12, s[40:43], s17 offen sc1
    s_waitcnt vmcnt(15)
    v_mfma_f32_16x16x32_bf16 v[32:35], v[216:219], v[92:95], v[32:35]
    v_mfma_f32_16x16x32_bf16 v[36:39], v[220:223], v[92:95], v[36:39]
    v_mfma_f32_16x16x32_bf16 v[40:43], v[224:227], v[92:95], v[40:43]
    v_mfma_f32_16x16x32_bf16 v[44:47], v[228:231], v[92:95], v[44:47]
    v_mfma_f32_16x16x32_bf16 v[48:51], v[232:235], v[92:95], v[48:51]
    buffer_load_dwordx4 v[92:95], v12, s[40:43], s18 offen sc1
    s_waitcnt vmcnt(10)
    v_mfma_f32_16x16x32_bf16 v[32:35], v[236:239], v[96:99], v[32:35]
    v_mfma_f32_16x16x32_bf16 v[36:39], v[240:243], v[96:99], v[36:39]
    v_mfma_f32_16x16x32_bf16 v[40:43], v[244:247], v[96:99], v[40:43]
    v_mfma_f32_16x16x32_bf16 v[44:47], v[248:251], v[96:99], v[44:47]
    v_mfma_f32_16x16x32_bf16 v[48:51], v[252:255], v[96:99], v[48:51]
    buffer_load_dwordx4 v[96:99], v12, s[40:43], s19 offen sc1
    s_waitcnt vmcnt(10)
    v_mfma_f32_16x16x32_bf16 v[52:55], v[116:119], v[100:103], 0
    v_mfma_f32_16x16x32_bf16 v[56:59], v[120:123], v[100:103], 0
    v_mfma_f32_16x16x32_bf16 v[60:63], v[124:127], v[100:103], 0
    v_mfma_f32_16x16x32_bf16 v[64:67], v[128:131], v[100:103], 0
    v_mfma_f32_16x16x32_bf16 v[68:71], v[132:135], v[100:103], 0
    buffer_load_dwordx4 v[100:103], v12, s[40:43], s20 offen sc1
    s_waitcnt vmcnt(10)
    s_mov_b32 s59, 1000000
L_lw_lconv_12:
    ds_read_b32 v29, v5
    s_waitcnt lgkmcnt(0)
    v_cmp_gt_u32 vcc, s95, v29
    s_cbranch_vccz L_lwd_lconv_13
    s_sleep 1
    s_sub_u32 s59, s59, 1
    s_cbranch_scc0 L_lw_lconv_12
L_lwd_lconv_13:
    v_mfma_f32_16x16x32_bf16 v[52:55], v[136:139], v[104:107], v[52:55]
    ds_write_b128 v15, v[32:35] offset:0
    v_mfma_f32_16x16x32_bf16 v[56:59], v[140:143], v[104:107], v[56:59]
    ds_write_b128 v15, v[36:39] offset:1024
    v_mfma_f32_16x16x32_bf16 v[60:63], v[144:147], v[104:107], v[60:63]
    ds_write_b128 v15, v[40:43] offset:2048
    v_mfma_f32_16x16x32_bf16 v[64:67], v[148:151], v[104:107], v[64:67]
    ds_write_b128 v15, v[44:47] offset:3072
    v_mfma_f32_16x16x32_bf16 v[68:71], v[152:155], v[104:107], v[68:71]
    ds_write_b128 v15, v[48:51] offset:4096
    v_mov_b32 v30, 2
    ds_write_b32 v27, v30 offset:32
    buffer_load_dwordx4 v[104:107], v12, s[40:43], s21 offen sc1
    s_waitcnt vmcnt(10)
    v_mfma_f32_16x16x32_bf16 v[52:55], v[156:159], v[108:111], v[52:55]
    v_mfma_f32_16x16x32_bf16 v[56:59], v[160:163], v[108:111], v[56:59]
    v_mfma_f32_16x16x32_bf16 v[60:63], v[164:167], v[108:111], v[60:63]
    v_mfma_f32_16x16x32_bf16 v[64:67], v[168:171], v[108:111], v[64:67]
    v_mfma_f32_16x16x32_bf16 v[68:71], v[172:175], v[108:111], v[68:71]
    buffer_load_dwordx4 v[108:111], v12, s[40:43], s22 offen sc1
    s_waitcnt vmcnt(10)
    v_mfma_f32_16x16x32_bf16 v[52:55], v[176:179], v[112:115], v[52:55]
    v_mfma_f32_16x16x32_bf16 v[56:59], v[180:183], v[112:115], v[56:59]
    v_mfma_f32_16x16x32_bf16 v[60:63], v[184:187], v[112:115], v[60:63]
    v_mfma_f32_16x16x32_bf16 v[64:67], v[188:191], v[112:115], v[64:67]
    v_mfma_f32_16x16x32_bf16 v[68:71], v[192:195], v[112:115], v[68:71]
    buffer_load_dwordx4 v[112:115], v13, s[40:43], s16 offen sc1
    s_waitcnt vmcnt(10)
    v_mfma_f32_16x16x32_bf16 v[52:55], v[196:199], v[72:75], v[52:55]
    v_mfma_f32_16x16x32_bf16 v[56:59], v[200:203], v[72:75], v[56:59]
    v_mfma_f32_16x16x32_bf16 v[60:63], v[204:207], v[72:75], v[60:63]
    v_mfma_f32_16x16x32_bf16 v[64:67], v[208:211], v[72:75], v[64:67]
    v_mfma_f32_16x16x32_bf16 v[68:71], v[212:215], v[72:75], v[68:71]
    v_mov_b32 v8, s48
    v_mov_b32 v9, s49
    s_mov_b32 exec_lo, 15
    s_mov_b32 exec_hi, 0
    v_mov_b32 v8, 0
    v_mov_b32 v9, 0
    buffer_atomic_or_x2 v[8:9], v18, s[36:39], 0 offen sc0 sc1
    s_mov_b64 exec, -1
    buffer_load_dwordx4 v[72:75], v13, s[40:43], s17 offen sc1
    s_waitcnt vmcnt(10)
    v_mfma_f32_16x16x32_bf16 v[52:55], v[216:219], v[76:79], v[52:55]
    v_mfma_f32_16x16x32_bf16 v[56:59], v[220:223], v[76:79], v[56:59]
    v_mfma_f32_16x16x32_bf16 v[60:63], v[224:227], v[76:79], v[60:63]
    v_mfma_f32_16x16x32_bf16 v[64:67], v[228:231], v[76:79], v[64:67]
    v_mfma_f32_16x16x32_bf16 v[68:71], v[232:235], v[76:79], v[68:71]
    buffer_load_dwordx4 v[76:79], v13, s[40:43], s18 offen sc1
    s_waitcnt vmcnt(10)
    v_mfma_f32_16x16x32_bf16 v[52:55], v[236:239], v[80:83], v[52:55]
    v_mfma_f32_16x16x32_bf16 v[56:59], v[240:243], v[80:83], v[56:59]
    v_mfma_f32_16x16x32_bf16 v[60:63], v[244:247], v[80:83], v[60:63]
    v_mfma_f32_16x16x32_bf16 v[64:67], v[248:251], v[80:83], v[64:67]
    v_mfma_f32_16x16x32_bf16 v[68:71], v[252:255], v[80:83], v[68:71]
    buffer_load_dwordx4 v[80:83], v13, s[40:43], s19 offen sc1
    s_waitcnt vmcnt(10)
    v_mfma_f32_16x16x32_bf16 v[32:35], v[116:119], v[84:87], 0
    v_mfma_f32_16x16x32_bf16 v[36:39], v[120:123], v[84:87], 0
    v_mfma_f32_16x16x32_bf16 v[40:43], v[124:127], v[84:87], 0
    v_mfma_f32_16x16x32_bf16 v[44:47], v[128:131], v[84:87], 0
    v_mfma_f32_16x16x32_bf16 v[48:51], v[132:135], v[84:87], 0
    buffer_load_dwordx4 v[84:87], v13, s[40:43], s20 offen sc1
    s_waitcnt vmcnt(10)
    v_mfma_f32_16x16x32_bf16 v[32:35], v[136:139], v[88:91], v[32:35]
    ds_write_b128 v15, v[52:55] offset:20480
    v_mfma_f32_16x16x32_bf16 v[36:39], v[140:143], v[88:91], v[36:39]
    ds_write_b128 v15, v[56:59] offset:21504
    v_mfma_f32_16x16x32_bf16 v[40:43], v[144:147], v[88:91], v[40:43]
    ds_write_b128 v15, v[60:63] offset:22528
    v_mfma_f32_16x16x32_bf16 v[44:47], v[148:151], v[88:91], v[44:47]
    ds_write_b128 v15, v[64:67] offset:23552
    v_mfma_f32_16x16x32_bf16 v[48:51], v[152:155], v[88:91], v[48:51]
    ds_write_b128 v15, v[68:71] offset:24576
    v_mov_b32 v30, 3
    ds_write_b32 v27, v30 offset:32
    buffer_load_dwordx4 v[88:91], v13, s[40:43], s21 offen sc1
    s_waitcnt vmcnt(10)
    v_mfma_f32_16x16x32_bf16 v[32:35], v[156:159], v[92:95], v[32:35]
    v_mfma_f32_16x16x32_bf16 v[36:39], v[160:163], v[92:95], v[36:39]
    v_mfma_f32_16x16x32_bf16 v[40:43], v[164:167], v[92:95], v[40:43]
    v_mfma_f32_16x16x32_bf16 v[44:47], v[168:171], v[92:95], v[44:47]
    v_mfma_f32_16x16x32_bf16 v[48:51], v[172:175], v[92:95], v[48:51]
    buffer_load_dwordx4 v[92:95], v13, s[40:43], s22 offen sc1
    s_waitcnt vmcnt(10)
    v_mfma_f32_16x16x32_bf16 v[32:35], v[176:179], v[96:99], v[32:35]
    v_mfma_f32_16x16x32_bf16 v[36:39], v[180:183], v[96:99], v[36:39]
    v_mfma_f32_16x16x32_bf16 v[40:43], v[184:187], v[96:99], v[40:43]
    v_mfma_f32_16x16x32_bf16 v[44:47], v[188:191], v[96:99], v[44:47]
    v_mfma_f32_16x16x32_bf16 v[48:51], v[192:195], v[96:99], v[48:51]
    s_waitcnt vmcnt(6)
    v_cmp_ne_u64 vcc, s[48:49], v[8:9]
    s_cbranch_vccz L_polld_h2_15
    s_mov_b32 s59, 20000
L_poll_h2_14:
    s_sleep 6
    v_mov_b32 v8, s48
    v_mov_b32 v9, s49
    s_mov_b32 exec_lo, 15
    s_mov_b32 exec_hi, 0
    v_mov_b32 v8, 0
    v_mov_b32 v9, 0
    buffer_atomic_or_x2 v[8:9], v18, s[36:39], 0 offen sc0 sc1
    s_mov_b64 exec, -1
    s_waitcnt vmcnt(0)
    v_cmp_ne_u64 vcc, s[48:49], v[8:9]
    s_cbranch_vccz L_polld_h2_15
    s_sub_u32 s59, s59, 1
    s_cbranch_scc0 L_poll_h2_14
L_polld_h2_15:
    buffer_load_dwordx4 v[96:99], v10, s[12:15], s16 offen sc1
    s_waitcnt vmcnt(10)
    v_mfma_f32_16x16x32_bf16 v[32:35], v[196:199], v[100:103], v[32:35]
    v_mfma_f32_16x16x32_bf16 v[36:39], v[200:203], v[100:103], v[36:39]
    v_mfma_f32_16x16x32_bf16 v[40:43], v[204:207], v[100:103], v[40:43]
    v_mfma_f32_16x16x32_bf16 v[44:47], v[208:211], v[100:103], v[44:47]
    v_mfma_f32_16x16x32_bf16 v[48:51], v[212:215], v[100:103], v[48:51]
    buffer_load_dwordx4 v[100:103], v10, s[12:15], s17 offen sc1
    s_waitcnt vmcnt(10)
    v_mfma_f32_16x16x32_bf16 v[32:35], v[216:219], v[104:107], v[32:35]
    v_mfma_f32_16x16x32_bf16 v[36:39], v[220:223], v[104:107], v[36:39]
    v_mfma_f32_16x16x32_bf16 v[40:43], v[224:227], v[104:107], v[40:43]
    v_mfma_f32_16x16x32_bf16 v[44:47], v[228:231], v[104:107], v[44:47]
    v_mfma_f32_16x16x32_bf16 v[48:51], v[232:235], v[104:107], v[48:51]
    buffer_load_dwordx4 v[104:107], v10, s[12:15], s18 offen sc1
    s_waitcnt vmcnt(10)
    v_mfma_f32_16x16x32_bf16 v[32:35], v[236:239], v[108:111], v[32:35]
    v_mfma_f32_16x16x32_bf16 v[36:39], v[240:243], v[108:111], v[36:39]
    v_mfma_f32_16x16x32_bf16 v[40:43], v[244:247], v[108:111], v[40:43]
    v_mfma_f32_16x16x32_bf16 v[44:47], v[248:251], v[108:111], v[44:47]
    v_mfma_f32_16x16x32_bf16 v[48:51], v[252:255], v[108:111], v[48:51]
    buffer_load_dwordx4 v[108:111], v10, s[12:15], s19 offen sc1
    s_waitcnt vmcnt(10)
    v_mfma_f32_16x16x32_bf16 v[52:55], v[116:119], v[112:115], 0
    v_mfma_f32_16x16x32_bf16 v[56:59], v[120:123], v[112:115], 0
    v_mfma_f32_16x16x32_bf16 v[60:63], v[124:127], v[112:115], 0
    v_mfma_f32_16x16x32_bf16 v[64:67], v[128:131], v[112:115], 0
    v_mfma_f32_16x16x32_bf16 v[68:71], v[132:135], v[112:115], 0
    buffer_load_dwordx4 v[112:115], v10, s[12:15], s20 offen sc1
    s_waitcnt vmcnt(10)
    v_mfma_f32_16x16x32_bf16 v[52:55], v[136:139], v[72:75], v[52:55]
    ds_write_b128 v15, v[32:35] offset:40960
    v_mfma_f32_16x16x32_bf16 v[56:59], v[140:143], v[72:75], v[56:59]
    ds_write_b128 v15, v[36:39] offset:41984
    v_mfma_f32_16x16x32_bf16 v[60:63], v[144:147], v[72:75], v[60:63]
    ds_write_b128 v15, v[40:43] offset:43008
    v_mfma_f32_16x16x32_bf16 v[64:67], v[148:151], v[72:75], v[64:67]
    ds_write_b128 v15, v[44:47] offset:44032
    v_mfma_f32_16x16x32_bf16 v[68:71], v[152:155], v[72:75], v[68:71]
    ds_write_b128 v15, v[48:51] offset:45056
    v_mov_b32 v30, 4
    ds_write_b32 v27, v30 offset:32
    buffer_load_dwordx4 v[72:75], v10, s[12:15], s21 offen sc1
    s_waitcnt vmcnt(10)
    v_mfma_f32_16x16x32_bf16 v[52:55], v[156:159], v[76:79], v[52:55]
    v_mfma_f32_16x16x32_bf16 v[56:59], v[160:163], v[76:79], v[56:59]
    v_mfma_f32_16x16x32_bf16 v[60:63], v[164:167], v[76:79], v[60:63]
    v_mfma_f32_16x16x32_bf16 v[64:67], v[168:171], v[76:79], v[64:67]
    v_mfma_f32_16x16x32_bf16 v[68:71], v[172:175], v[76:79], v[68:71]
    buffer_load_dwordx4 v[76:79], v10, s[12:15], s22 offen sc1
    s_waitcnt vmcnt(10)
    v_mfma_f32_16x16x32_bf16 v[52:55], v[176:179], v[80:83], v[52:55]
    v_mfma_f32_16x16x32_bf16 v[56:59], v[180:183], v[80:83], v[56:59]
    v_mfma_f32_16x16x32_bf16 v[60:63], v[184:187], v[80:83], v[60:63]
    v_mfma_f32_16x16x32_bf16 v[64:67], v[188:191], v[80:83], v[64:67]
    v_mfma_f32_16x16x32_bf16 v[68:71], v[192:195], v[80:83], v[68:71]
    buffer_load_dwordx4 v[80:83], v11, s[12:15], s16 offen sc1
    s_waitcnt vmcnt(10)
    v_mfma_f32_16x16x32_bf16 v[52:55], v[196:199], v[84:87], v[52:55]
    v_mfma_f32_16x16x32_bf16 v[56:59], v[200:203], v[84:87], v[56:59]
    v_mfma_f32_16x16x32_bf16 v[60:63], v[204:207], v[84:87], v[60:63]
    v_mfma_f32_16x16x32_bf16 v[64:67], v[208:211], v[84:87], v[64:67]
    v_mfma_f32_16x16x32_bf16 v[68:71], v[212:215], v[84:87], v[68:71]
    buffer_load_dwordx4 v[84:87], v11, s[12:15], s17 offen sc1
    s_waitcnt vmcnt(10)
    v_mfma_f32_16x16x32_bf16 v[52:55], v[216:219], v[88:91], v[52:55]
    v_mfma_f32_16x16x32_bf16 v[56:59], v[220:223], v[88:91], v[56:59]
    v_mfma_f32_16x16x32_bf16 v[60:63], v[224:227], v[88:91], v[60:63]
    v_mfma_f32_16x16x32_bf16 v[64:67], v[228:231], v[88:91], v[64:67]
    v_mfma_f32_16x16x32_bf16 v[68:71], v[232:235], v[88:91], v[68:71]
    buffer_load_dwordx4 v[88:91], v11, s[12:15], s18 offen sc1
    s_waitcnt vmcnt(10)
    v_mfma_f32_16x16x32_bf16 v[52:55], v[236:239], v[92:95], v[52:55]
    v_mfma_f32_16x16x32_bf16 v[56:59], v[240:243], v[92:95], v[56:59]
    v_mfma_f32_16x16x32_bf16 v[60:63], v[244:247], v[92:95], v[60:63]
    v_mfma_f32_16x16x32_bf16 v[64:67], v[248:251], v[92:95], v[64:67]
    v_mfma_f32_16x16x32_bf16 v[68:71], v[252:255], v[92:95], v[68:71]
    buffer_load_dwordx4 v[92:95], v11, s[12:15], s19 offen sc1
    s_waitcnt vmcnt(10)
    v_mfma_f32_16x16x32_bf16 v[32:35], v[116:119], v[96:99], 0
    v_mfma_f32_16x16x32_bf16 v[36:39], v[120:123], v[96:99], 0
    v_mfma_f32_16x16x32_bf16 v[40:43], v[124:127], v[96:99], 0
    v_mfma_f32_16x16x32_bf16 v[44:47], v[128:131], v[96:99], 0
    v_mfma_f32_16x16x32_bf16 v[48:51], v[132:135], v[96:99], 0
    buffer_load_dwordx4 v[96:99], v11, s[12:15], s20 offen sc1
    s_waitcnt vmcnt(10)
    v_mfma_f32_16x16x32_bf16 v[32:35], v[136:139], v[100:103], v[32:35]
    ds_write_b128 v14, v[52:55] offset:0
    v_mfma_f32_16x16x32_bf16 v[36:39], v[140:143], v[100:103], v[36:39]
    ds_write_b128 v14, v[56:59] offset:1024
    v_mfma_f32_16x16x32_bf16 v[40:43], v[144:147], v[100:103], v[40:43]
    ds_write_b128 v14, v[60:63] offset:2048
    v_mfma_f32_16x16x32_bf16 v[44:47], v[148:151], v[100:103], v[44:47]
    ds_write_b128 v14, v[64:67] offset:3072
    v_mfma_f32_16x16x32_bf16 v[48:51], v[152:155], v[100:103], v[48:51]
    ds_write_b128 v14, v[68:71] offset:4096
    v_mov_b32 v30, 5
    ds_write_b32 v27, v30 offset:32
    buffer_load_dwordx4 v[100:103], v11, s[12:15], s21 offen sc1
    s_waitcnt vmcnt(10)
    v_mfma_f32_16x16x32_bf16 v[32:35], v[156:159], v[104:107], v[32:35]
    v_mfma_f32_16x16x32_bf16 v[36:39], v[160:163], v[104:107], v[36:39]
    v_mfma_f32_16x16x32_bf16 v[40:43], v[164:167], v[104:107], v[40:43]
    v_mfma_f32_16x16x32_bf16 v[44:47], v[168:171], v[104:107], v[44:47]
    v_mfma_f32_16x16x32_bf16 v[48:51], v[172:175], v[104:107], v[48:51]
    buffer_load_dwordx4 v[104:107], v11, s[12:15], s22 offen sc1
    s_waitcnt vmcnt(10)
    v_mfma_f32_16x16x32_bf16 v[32:35], v[176:179], v[108:111], v[32:35]
    v_mfma_f32_16x16x32_bf16 v[36:39], v[180:183], v[108:111], v[36:39]
    v_mfma_f32_16x16x32_bf16 v[40:43], v[184:187], v[108:111], v[40:43]
    v_mfma_f32_16x16x32_bf16 v[44:47], v[188:191], v[108:111], v[44:47]
    v_mfma_f32_16x16x32_bf16 v[48:51], v[192:195], v[108:111], v[48:51]
    buffer_load_dwordx4 v[108:111], v12, s[12:15], s16 offen sc1
    s_waitcnt vmcnt(10)
    v_mfma_f32_16x16x32_bf16 v[32:35], v[196:199], v[112:115], v[32:35]
    v_mfma_f32_16x16x32_bf16 v[36:39], v[200:203], v[112:115], v[36:39]
    v_mfma_f32_16x16x32_bf16 v[40:43], v[204:207], v[112:115], v[40:43]
    v_mfma_f32_16x16x32_bf16 v[44:47], v[208:211], v[112:115], v[44:47]
    v_mfma_f32_16x16x32_bf16 v[48:51], v[212:215], v[112:115], v[48:51]
    buffer_load_dwordx4 v[112:115], v12, s[12:15], s17 offen sc1
    s_waitcnt vmcnt(10)
    v_mfma_f32_16x16x32_bf16 v[32:35], v[216:219], v[72:75], v[32:35]
    v_mfma_f32_16x16x32_bf16 v[36:39], v[220:223], v[72:75], v[36:39]
    v_mfma_f32_16x16x32_bf16 v[40:43], v[224:227], v[72:75], v[40:43]
    v_mfma_f32_16x16x32_bf16 v[44:47], v[228:231], v[72:75], v[44:47]
    v_mfma_f32_16x16x32_bf16 v[48:51], v[232:235], v[72:75], v[48:51]
    buffer_load_dwordx4 v[72:75], v12, s[12:15], s18 offen sc1
    s_waitcnt vmcnt(10)
    v_mfma_f32_16x16x32_bf16 v[32:35], v[236:239], v[76:79], v[32:35]
    v_mfma_f32_16x16x32_bf16 v[36:39], v[240:243], v[76:79], v[36:39]
    v_mfma_f32_16x16x32_bf16 v[40:43], v[244:247], v[76:79], v[40:43]
    v_mfma_f32_16x16x32_bf16 v[44:47], v[248:251], v[76:79], v[44:47]
    v_mfma_f32_16x16x32_bf16 v[48:51], v[252:255], v[76:79], v[48:51]
    buffer_load_dwordx4 v[76:79], v12, s[12:15], s19 offen sc1
    s_waitcnt vmcnt(10)
    v_mfma_f32_16x16x32_bf16 v[52:55], v[116:119], v[80:83], 0
    v_mfma_f32_16x16x32_bf16 v[56:59], v[120:123], v[80:83], 0
    v_mfma_f32_16x16x32_bf16 v[60:63], v[124:127], v[80:83], 0
    v_mfma_f32_16x16x32_bf16 v[64:67], v[128:131], v[80:83], 0
    v_mfma_f32_16x16x32_bf16 v[68:71], v[132:135], v[80:83], 0
    buffer_load_dwordx4 v[80:83], v12, s[12:15], s20 offen sc1
    s_waitcnt vmcnt(10)
    v_mov_b32 v4, 163824
    s_mov_b32 s59, 1000000
L_lw_fr_16:
    ds_read_b32 v29, v4
    s_waitcnt lgkmcnt(0)
    v_cmp_gt_u32 vcc, 2, v29
    s_cbranch_vccz L_lwd_fr_17
    s_sleep 1
    s_sub_u32 s59, s59, 1
    s_cbranch_scc0 L_lw_fr_16
L_lwd_fr_17:
    v_mfma_f32_16x16x32_bf16 v[52:55], v[136:139], v[84:87], v[52:55]
    ds_write_b128 v15, v[32:35] offset:0
    v_mfma_f32_16x16x32_bf16 v[56:59], v[140:143], v[84:87], v[56:59]
    ds_write_b128 v15, v[36:39] offset:1024
    v_mfma_f32_16x16x32_bf16 v[60:63], v[144:147], v[84:87], v[60:63]
    ds_write_b128 v15, v[40:43] offset:2048
    v_mfma_f32_16x16x32_bf16 v[64:67], v[148:151], v[84:87], v[64:67]
    ds_write_b128 v15, v[44:47] offset:3072
    v_mfma_f32_16x16x32_bf16 v[68:71], v[152:155], v[84:87], v[68:71]
    ds_write_b128 v15, v[48:51] offset:4096
    v_mov_b32 v30, 6
    ds_write_b32 v27, v30 offset:32
    buffer_load_dwordx4 v[84:87], v12, s[12:15], s21 offen sc1
    s_waitcnt vmcnt(10)
    v_mfma_f32_16x16x32_bf16 v[52:55], v[156:159], v[88:91], v[52:55]
    v_mfma_f32_16x16x32_bf16 v[56:59], v[160:163], v[88:91], v[56:59]
    v_mfma_f32_16x16x32_bf16 v[60:63], v[164:167], v[88:91], v[60:63]
    v_mfma_f32_16x16x32_bf16 v[64:67], v[168:171], v[88:91], v[64:67]
    v_mfma_f32_16x16x32_bf16 v[68:71], v[172:175], v[88:91], v[68:71]
    buffer_load_dwordx4 v[88:91], v12, s[12:15], s22 offen sc1
    s_waitcnt vmcnt(10)
    v_mfma_f32_16x16x32_bf16 v[52:55], v[176:179], v[92:95], v[52:55]
    v_mfma_f32_16x16x32_bf16 v[56:59], v[180:183], v[92:95], v[56:59]
    v_mfma_f32_16x16x32_bf16 v[60:63], v[184:187], v[92:95], v[60:63]
    v_mfma_f32_16x16x32_bf16 v[64:67], v[188:191], v[92:95], v[64:67]
    v_mfma_f32_16x16x32_bf16 v[68:71], v[192:195], v[92:95], v[68:71]
    buffer_load_dwordx4 v[92:95], v13, s[12:15], s16 offen sc1
    s_waitcnt vmcnt(10)
    v_mfma_f32_16x16x32_bf16 v[52:55], v[196:199], v[96:99], v[52:55]
    v_mfma_f32_16x16x32_bf16 v[56:59], v[200:203], v[96:99], v[56:59]
    v_mfma_f32_16x16x32_bf16 v[60:63], v[204:207], v[96:99], v[60:63]
    v_mfma_f32_16x16x32_bf16 v[64:67], v[208:211], v[96:99], v[64:67]
    v_mfma_f32_16x16x32_bf16 v[68:71], v[212:215], v[96:99], v[68:71]
    buffer_load_dwordx4 v[96:99], v13, s[12:15], s17 offen sc1
    s_waitcnt vmcnt(10)
    v_mfma_f32_16x16x32_bf16 v[52:55], v[216:219], v[100:103], v[52:55]
    v_mfma_f32_16x16x32_bf16 v[56:59], v[220:223], v[100:103], v[56:59]
    v_mfma_f32_16x16x32_bf16 v[60:63], v[224:227], v[100:103], v[60:63]
    v_mfma_f32_16x16x32_bf16 v[64:67], v[228:231], v[100:103], v[64:67]
    v_mfma_f32_16x16x32_bf16 v[68:71], v[232:235], v[100:103], v[68:71]
    buffer_load_dwordx4 v[100:103], v13, s[12:15], s18 offen sc1
    s_waitcnt vmcnt(10)
    v_mfma_f32_16x16x32_bf16 v[52:55], v[236:239], v[104:107], v[52:55]
    v_mfma_f32_16x16x32_bf16 v[56:59], v[240:243], v[104:107], v[56:59]
    v_mfma_f32_16x16x32_bf16 v[60:63], v[244:247], v[104:107], v[60:63]
    v_mfma_f32_16x16x32_bf16 v[64:67], v[248:251], v[104:107], v[64:67]
    v_mfma_f32_16x16x32_bf16 v[68:71], v[252:255], v[104:107], v[68:71]
    buffer_load_dwordx4 v[104:107], v13, s[12:15], s19 offen sc1
    s_waitcnt vmcnt(10)
    v_mfma_f32_16x16x32_bf16 v[32:35], v[116:119], v[108:111], 0
    v_mfma_f32_16x16x32_bf16 v[36:39], v[120:123], v[108:111], 0
    v_mfma_f32_16x16x32_bf16 v[40:43], v[124:127], v[108:111], 0
    v_mfma_f32_16x16x32_bf16 v[44:47], v[128:131], v[108:111], 0
    v_mfma_f32_16x16x32_bf16 v[48:51], v[132:135], v[108:111], 0
    buffer_load_dwordx4 v[108:111], v13, s[12:15], s20 offen sc1
    s_waitcnt vmcnt(10)
    v_mov_b32 v4, 163828
    s_mov_b32 s59, 1000000
L_lw_fr_18:
    ds_read_b32 v29, v4
    s_waitcnt lgkmcnt(0)
    v_cmp_gt_u32 vcc, 2, v29
    s_cbranch_vccz L_lwd_fr_19
    s_sleep 1
    s_sub_u32 s59, s59, 1
    s_cbranch_scc0 L_lw_fr_18
L_lwd_fr_19:
    v_mfma_f32_16x16x32_bf16 v[32:35], v[136:139], v[112:115], v[32:35]
    ds_write_b128 v15, v[52:55] offset:20480
    v_mfma_f32_16x16x32_bf16 v[36:39], v[140:143], v[112:115], v[36:39]
    ds_write_b128 v15, v[56:59] offset:21504
    v_mfma_f32_16x16x32_bf16 v[40:43], v[144:147], v[112:115], v[40:43]
    ds_write_b128 v15, v[60:63] offset:22528
    v_mfma_f32_16x16x32_bf16 v[44:47], v[148:151], v[112:115], v[44:47]
    ds_write_b128 v15, v[64:67] offset:23552
    v_mfma_f32_16x16x32_bf16 v[48:51], v[152:155], v[112:115], v[48:51]
    ds_write_b128 v15, v[68:71] offset:24576
    v_mov_b32 v30, 7
    ds_write_b32 v27, v30 offset:32
    buffer_load_dwordx4 v[112:115], v13, s[12:15], s21 offen sc1
    s_waitcnt vmcnt(10)
    v_mfma_f32_16x16x32_bf16 v[32:35], v[156:159], v[72:75], v[32:35]
    v_mfma_f32_16x16x32_bf16 v[36:39], v[160:163], v[72:75], v[36:39]
    v_mfma_f32_16x16x32_bf16 v[40:43], v[164:167], v[72:75], v[40:43]
    v_mfma_f32_16x16x32_bf16 v[44:47], v[168:171], v[72:75], v[44:47]
    v_mfma_f32_16x16x32_bf16 v[48:51], v[172:175], v[72:75], v[48:51]
    buffer_load_dwordx4 v[72:75], v13, s[12:15], s22 offen sc1
    s_waitcnt vmcnt(10)
    v_mfma_f32_16x16x32_bf16 v[32:35], v[176:179], v[76:79], v[32:35]
    v_mfma_f32_16x16x32_bf16 v[36:39], v[180:183], v[76:79], v[36:39]
    v_mfma_f32_16x16x32_bf16 v[40:43], v[184:187], v[76:79], v[40:43]
    v_mfma_f32_16x16x32_bf16 v[44:47], v[188:191], v[76:79], v[44:47]
    v_mfma_f32_16x16x32_bf16 v[48:51], v[192:195], v[76:79], v[48:51]
    s_waitcnt vmcnt(9)
    v_mfma_f32_16x16x32_bf16 v[32:35], v[196:199], v[80:83], v[32:35]
    v_mfma_f32_16x16x32_bf16 v[36:39], v[200:203], v[80:83], v[36:39]
    v_mfma_f32_16x16x32_bf16 v[40:43], v[204:207], v[80:83], v[40:43]
    v_mfma_f32_16x16x32_bf16 v[44:47], v[208:211], v[80:83], v[44:47]
    v_mfma_f32_16x16x32_bf16 v[48:51], v[212:215], v[80:83], v[48:51]
    s_waitcnt vmcnt(8)
    v_mfma_f32_16x16x32_bf16 v[32:35], v[216:219], v[84:87], v[32:35]
    v_mfma_f32_16x16x32_bf16 v[36:39], v[220:223], v[84:87], v[36:39]
    v_mfma_f32_16x16x32_bf16 v[40:43], v[224:227], v[84:87], v[40:43]
    v_mfma_f32_16x16x32_bf16 v[44:47], v[228:231], v[84:87], v[44:47]
    v_mfma_f32_16x16x32_bf16 v[48:51], v[232:235], v[84:87], v[48:51]
    s_waitcnt vmcnt(7)
    v_mfma_f32_16x16x32_bf16 v[32:35], v[236:239], v[88:91], v[32:35]
    v_mfma_f32_16x16x32_bf16 v[36:39], v[240:243], v[88:91], v[36:39]
    v_mfma_f32_16x16x32_bf16 v[40:43], v[244:247], v[88:91], v[40:43]
    v_mfma_f32_16x16x32_bf16 v[44:47], v[248:251], v[88:91], v[44:47]
    v_mfma_f32_16x16x32_bf16 v[48:51], v[252:255], v[88:91], v[48:51]
    s_waitcnt vmcnt(6)
    v_mfma_f32_16x16x32_bf16 v[52:55], v[116:119], v[92:95], 0
    v_mfma_f32_16x16x32_bf16 v[56:59], v[120:123], v[92:95], 0
    v_mfma_f32_16x16x32_bf16 v[60:63], v[124:127], v[92:95], 0
    v_mfma_f32_16x16x32_bf16 v[64:67], v[128:131], v[92:95], 0
    v_mfma_f32_16x16x32_bf16 v[68:71], v[132:135], v[92:95], 0
    s_waitcnt vmcnt(5)
    v_mov_b32 v4, 163832
    s_mov_b32 s59, 1000000
L_lw_fr_20:
    ds_read_b32 v29, v4
    s_waitcnt lgkmcnt(0)
    v_cmp_gt_u32 vcc, 2, v29
    s_cbranch_vccz L_lwd_fr_21
    s_sleep 1
    s_sub_u32 s59, s59, 1
    s_cbranch_scc0 L_lw_fr_20
L_lwd_fr_21:
    v_mfma_f32_16x16x32_bf16 v[52:55], v[136:139], v[96:99], v[52:55]
    ds_write_b128 v15, v[32:35] offset:40960
    v_mfma_f32_16x16x32_bf16 v[56:59], v[140:143], v[96:99], v[56:59]
    ds_write_b128 v15, v[36:39] offset:41984
    v_mfma_f32_16x16x32_bf16 v[60:63], v[144:147], v[96:99], v[60:63]
    ds_write_b128 v15, v[40:43] offset:43008
    v_mfma_f32_16x16x32_bf16 v[64:67], v[148:151], v[96:99], v[64:67]
    ds_write_b128 v15, v[44:47] offset:44032
    v_mfma_f32_16x16x32_bf16 v[68:71], v[152:155], v[96:99], v[68:71]
    ds_write_b128 v15, v[48:51] offset:45056
    v_mov_b32 v30, 8
    ds_write_b32 v27, v30 offset:32
    s_waitcnt vmcnt(4)
    v_mfma_f32_16x16x32_bf16 v[52:55], v[156:159], v[100:103], v[52:55]
    v_mfma_f32_16x16x32_bf16 v[56:59], v[160:163], v[100:103], v[56:59]
    v_mfma_f32_16x16x32_bf16 v[60:63], v[164:167], v[100:103], v[60:63]
    v_mfma_f32_16x16x32_bf16 v[64:67], v[168:171], v[100:103], v[64:67]
    v_mfma_f32_16x16x32_bf16 v[68:71], v[172:175], v[100:103], v[68:71]
    s_waitcnt vmcnt(3)
    v_mfma_f32_16x16x32_bf16 v[52:55], v[176:179], v[104:107], v[52:55]
    v_mfma_f32_16x16x32_bf16 v[56:59], v[180:183], v[104:107], v[56:59]
    v_mfma_f32_16x16x32_bf16 v[60:63], v[184:187], v[104:107], v[60:63]
    v_mfma_f32_16x16x32_bf16 v[64:67], v[188:191], v[104:107], v[64:67]
    v_mfma_f32_16x16x32_bf16 v[68:71], v[192:195], v[104:107], v[68:71]
    s_waitcnt vmcnt(2)
    v_mfma_f32_16x16x32_bf16 v[52:55], v[196:199], v[108:111], v[52:55]
    v_mfma_f32_16x16x32_bf16 v[56:59], v[200:203], v[108:111], v[56:59]
    v_mfma_f32_16x16x32_bf16 v[60:63], v[204:207], v[108:111], v[60:63]
    v_mfma_f32_16x16x32_bf16 v[64:67], v[208:211], v[108:111], v[64:67]
    v_mfma_f32_16x16x32_bf16 v[68:71], v[212:215], v[108:111], v[68:71]
    s_waitcnt vmcnt(1)
    v_mfma_f32_16x16x32_bf16 v[52:55], v[216:219], v[112:115], v[52:55]
    v_mfma_f32_16x16x32_bf16 v[56:59], v[220:223], v[112:115], v[56:59]
    v_mfma_f32_16x16x32_bf16 v[60:63], v[224:227], v[112:115], v[60:63]
    v_mfma_f32_16x16x32_bf16 v[64:67], v[228:231], v[112:115], v[64:67]
    v_mfma_f32_16x16x32_bf16 v[68:71], v[232:235], v[112:115], v[68:71]
    s_waitcnt vmcnt(0)
    v_mfma_f32_16x16x32_bf16 v[52:55], v[236:239], v[72:75], v[52:55]
    v_mfma_f32_16x16x32_bf16 v[56:59], v[240:243], v[72:75], v[56:59]
    v_mfma_f32_16x16x32_bf16 v[60:63], v[244:247], v[72:75], v[60:63]
    v_mfma_f32_16x16x32_bf16 v[64:67], v[248:251], v[72:75], v[64:67]
    v_mfma_f32_16x16x32_bf16 v[68:71], v[252:255], v[72:75], v[68:71]
    v_mov_b32 v4, 163836
    s_mov_b32 s59, 1000000
L_lw_fr_22:
    ds_read_b32 v29, v4
    s_waitcnt lgkmcnt(0)
    v_cmp_gt_u32 vcc, 2, v29
    s_cbranch_vccz L_lwd_fr_23
    s_sleep 1
    s_sub_u32 s59, s59, 1
    s_cbranch_scc0 L_lw_fr_22
L_lwd_fr_23:
    s_nop 2
    ds_write_b128 v14, v[52:55] offset:0
    ds_write_b128 v14, v[56:59] offset:1024
    ds_write_b128 v14, v[60:63] offset:2048
    ds_write_b128 v14, v[64:67] offset:3072
    ds_write_b128 v14, v[68:71] offset:4096
    v_mov_b32 v30, 9
    ds_write_b32 v27, v30 offset:32
    s_branch L_fin
L_g1l:
    s_mov_b64 s[24:25], s[78:79]
    s_mov_b32 s26, 2211840
    s_mov_b32 s27, 0x20000
    s_mul_i32 s62, s51, 37
    s_lshr_b32 s62, s62, 8
    s_mul_i32 s63, s62, 7
    s_sub_u32 s63, s51, s63
    s_lshr_b32 s61, s50, 1
    s_lshl_b32 s53, s61, 2
    s_add_u32 s53, s53, s62
    s_mul_i32 s54, s97, 7
    s_add_u32 s54, s54, s63
    s_lshl_b32 s55, s54, 7
    s_min_u32 s55, s55, 1600
    s_mul_i32 s6, s61, 5
    s_add_u32 s6, s6, 1
    s_lshr_b32 s6, s6, 1
    s_add_u32 s62, s62, s63
    s_and_b32 s62, s62, 1
    s_mul_i32 s62, s62, 5
    s_add_u32 s6, s6, s62
    s_cmp_ge_u32 s6, 10
    s_cselect_b32 s62, 10, 0
    s_sub_u32 s6, s6, s62
    s_mov_b64 s[8:9], s[64:65]
    s_mov_b32 s10, 2621440
    s_mov_b32 s11, 0x20000
    s_lshl_b32 s4, s6, 7
    s_mul_i32 s5, s6, 221184
    v_lshrrev_b32 v4, 3, v1
    v_and_b32 v5, 7, v1
    v_xor_b32 v5, v5, v4
    s_lshl_b32 s63, s53, 7
    s_lshl_b32 s3, s52, 5
    s_add_u32 s63, s63, s3
    v_add_u32 v4, s63, v4
    v_mul_u32_u24 v4, 1280, v4
    v_lshl_add_u32 v120, v5, 4, v4
    v_add_u32 v121, 9216, v120
    v_add_u32 v122, 18432, v120
    v_add_u32 v123, 27648, v120
    v_lshrrev_b32 v4, 4, v1
    v_bfe_u32 v5, v1, 1, 3
    v_xor_b32 v5, v5, v4
    v_and_b32 v6, 1, v1
    v_lshlrev_b32 v6, 4, v6
    s_lshl_b32 s3, s52, 4
    v_add_u32 v7, s3, v4
    v_mul_u32_u24 v7, 3456, v7
    s_lshl_b32 s3, s55, 1
    v_add3_u32 v7, v7, v6, s3
    v_lshl_add_u32 v124, v5, 5, v7
    v_add_u32 v125, 12800, v124
    v_xor_b32 v5, 4, v5
    v_lshl_add_u32 v126, v5, 5, v7
    v_add_u32 v126, 25600, v126
    v_add_u32 v127, 12800, v126
    s_lshl_b32 s3, s52, 12
    s_barrier
    s_add_u32 m0, s3, 0
    s_nop 0
    buffer_load_dwordx4 v120, s[8:11], s4 offen offset:0  lds
    buffer_load_dwordx4 v121, s[8:11], s4 offen offset:1024  lds
    buffer_load_dwordx4 v122, s[8:11], s4 offen offset:2048  lds
    buffer_load_dwordx4 v123, s[8:11], s4 offen offset:3072  lds
    s_add_u32 m0, s3, 16384
    s_add_u32 s4, s4, 128
    buffer_load_dwordx4 v124, s[24:27], s5 offen offset:0  lds
    buffer_load_dwordx4 v125, s[24:27], s5 offen offset:1024  lds
    buffer_load_dwordx4 v126, s[24:27], s5 offen offset:2048  lds
    buffer_load_dwordx4 v127, s[24:27], s5 offen offset:3072  lds
    s_add_u32 s5, s5, 221184
    s_cmp_eq_u32 s4, 1280
    s_cselect_b32 s4, 0, s4
    s_cselect_b32 s5, 0, s5
    s_mov_b64 s[36:37], s[86:87]
    s_mov_b32 s38, 268435456
    s_mov_b32 s39, 0x20000
    s_mov_b64 s[20:21], s[72:73]
    s_mov_b32 s22, 2621440
    s_mov_b32 s23, 0x20000
    s_mov_b64 s[44:45], s[74:75]
    s_mov_b32 s46, 1280
    s_mov_b32 s47, 0x20000
    s_mov_b64 s[32:33], s[82:83]
    s_mov_b32 s34, 2621440
    s_mov_b32 s35, 0x20000
    s_waitcnt lgkmcnt(0)
    s_add_u32 s48, s48, 0x7F4A7C15
    s_addc_u32 s49, s49, 0x9E3779B9
    v_mov_b32 v24, s48
    v_mov_b32 v25, s49
    v_and_b32 v4, 15, v1
    v_lshrrev_b32 v5, 4, v1
    v_lshrrev_b32 v6, 2, v4
    v_and_b32 v7, 1, v5
    v_lshl_or_b32 v7, v7, 2, v6
    v_lshl_add_u32 v8, v5, 3, v6
    v_lshlrev_b32 v8, 8, v8
    v_and_b32 v9, 3, v1
    v_lshl_add_u32 v8, v9, 3, v8
    s_and_b32 s90, s53, 3
    s_min_u32 s90, s90, 2
    s_lshl_b32 s60, s90, 15
    s_add_u32 s60, s60, 16384
    v_add_u32 v8, s60, v8
    s_add_u32 s6, s6, s90
    s_cmp_ge_u32 s6, 10
    s_cselect_b32 s60, 10, 0
    s_sub_u32 s6, s6, s60
    s_lshl_b32 s63, s52, 1
    v_xor_b32 v7, s63, v7
    v_lshl_add_u32 v132, v7, 5, v8
    v_xor_b32 v133, 32, v132
    v_mov_b32 v136, 0x3f803f80
    v_mov_b32 v137, 0x3f803f80
    v_mov_b32 v138, 0x3f803f80
    v_mov_b32 v139, 0x3f803f80
    v_lshrrev_b32 v6, 1, v4
    v_lshlrev_b32 v6, 3, v6
    v_lshl_add_u32 v6, v5, 1, v6
    v_and_b32 v7, 1, v4
    v_add_u32 v6, v6, v7
    v_lshlrev_b32 v135, 4, v6
    s_mul_i32 s60, s6, 0x3600
    s_lshl_b32 s61, s55, 3
    s_add_u32 s60, s60, s61
    s_lshl_b32 s61, s52, 8
    s_add_u32 s60, s60, s61
    s_add_u32 s88, s60, 524288
    v_mov_b32 v178, s48
    v_mov_b32 v179, s49
    s_lshl_b32 s60, s53, 11
    s_add_u32 s60, s60, 98304
    v_add_u32 v10, s60, v2
    s_min_u32 s93, s52, 2
    s_lshl_b32 s60, s55, 3
    s_lshl_b32 s61, s93, 9
    s_add_u32 s60, s60, s61
    s_add_u32 s60, s60, 523776
    v_lshrrev_b32 v8, 5, v1
    v_mul_u32_u24 v8, 0x3600, v8
    v_and_b32 v13, 31, v1
    v_lshl_add_u32 v8, v13, 4, v8
    v_add_u32 v8, s60, v8
    s_cmp_eq_u32 s52, 0
    s_cselect_b32 s94, 1024, -1
    s_cselect_b64 vcc, -1, 0
    v_cndmask_b32 v10, v8, v10, vcc
    s_mov_b64 s[28:29], s[80:81]
    s_mov_b32 s30, 2211840
    s_mov_b32 s31, 0x20000
    s_mul_i32 s60, s2, 6554
    s_lshr_b32 s60, s60, 16
    s_mul_i32 s61, s60, 10
    s_sub_u32 s61, s2, s61
    s_mul_i32 s60, s60, 81920
    s_lshl_b32 s61, s61, 7
    s_add_u32 s60, s60, s61
    s_mul_i32 s61, s52, 20480
    s_add_u32 s60, s60, s61
    v_lshrrev_b32 v180, 3, v1
    v_mul_u32_u24 v180, 1280, v180
    v_and_b32 v181, 7, v1
    v_lshl_add_u32 v180, v181, 4, v180
    s_lshl_b32 s61, s52, 11
    s_add_u32 s17, s61, 147968
    v_add_u32 v181, 9216, v180
    s_mov_b32 s16, s60
    v_bfe_u32 v182, v1, 2, 2
    v_lshrrev_b32 v183, 4, v1
    v_lshl_add_u32 v182, v183, 2, v182
    v_lshlrev_b32 v182, 7, v182
    v_and_b32 v183, 3, v1
    v_lshl_add_u32 v182, v183, 3, v182
    s_lshr_b32 s60, s52, 1
    s_lshl_b32 s60, s60, 12
    s_and_b32 s61, s52, 1
    s_lshl_b32 s61, s61, 6
    s_add_u32 s60, s60, s61
    s_add_u32 s60, s60, 147968
    v_add_u32 v182, s60, v182
    s_mul_i32 s60, s2, 6554
    s_lshr_b32 s60, s60, 16
    s_mul_i32 s61, s60, 10
    s_sub_u32 s61, s2, s61
    s_lshl_b32 s62, s61, 5
    s_add_u32 s62, s62, s60
    s_lshl_b32 s62, s62, 3
    s_add_u32 s89, s62, 786432
    s_lshl_b32 s60, s60, 1
    s_lshr_b32 s62, s52, 1
    s_add_u32 s60, s60, s62
    s_lshl_b32 s61, s61, 1
    s_and_b32 s62, s52, 1
    s_add_u32 s61, s61, s62
    s_mul_i32 s60, s60, 5120
    s_add_u32 s60, s60, 6291456
    s_lshl_b32 s61, s61, 1
    s_add_u32 s62, s61, 0
    s_mul_i32 s63, s62, 52
    s_lshr_b32 s63, s63, 8
    s_mul_i32 s63, s63, 271360
    s_lshl_b32 s62, s62, 10
    s_add_u32 s63, s63, s62
    s_add_u32 s63, s63, s60
    s_mov_b32 s14, s63
    s_add_u32 s62, s61, 1
    s_mul_i32 s63, s62, 52
    s_lshr_b32 s63, s63, 8
    s_mul_i32 s63, s63, 271360
    s_lshl_b32 s62, s62, 10
    s_add_u32 s63, s63, s62
    s_add_u32 s63, s63, s60
    s_mov_b32 s15, s63
    s_and_b32 s60, s52, 1
    s_mul_i32 s61, s60, 8448
    s_add_u32 s95, s61, 131072
    s_add_u32 s18, s61, 81984
    s_mul_i32 s61, s60, 4608
    s_add_u32 s92, s61, 99072
    s_lshl_b32 s58, s2, 1
    s_add_u32 s58, s58, s60
    s_add_u32 s58, s58, 128
    s_mov_b32 s98, 108288
    s_mov_b32 s19, 147968
    s_lshl_b32 s96, s58, 12
    s_lshr_b32 s6, s52, 1
    s_mul_i32 s60, s6, 4224
    s_add_u32 s60, s60, s95
    s_add_u32 s12, s60, 32
    s_lshl_b32 s61, s6, 2
    s_add_u32 s61, s61, s96
    v_add_u32 v16, s60, v2
    s_mov_b32 s13, s61
    v_lshrrev_b32 v6, 4, v1
    v_and_b32 v7, 15, v1
    v_add_u32 v33, v6, v7
    v_subrev_u32 v33, 16, v33
    v_lshlrev_b32 v33, 1, v33
    v_cmp_gt_i32 vcc, 0, v33
    v_mov_b32 v34, 0x80000000
    s_lshl_b32 s61, s58, 1
    v_cndmask_b32 v33, v33, v34, vcc
    s_cmp_eq_u32 s6, 0
    s_cselect_b32 s61, s61, 0x80000000
    s_mov_b32 s40, s61
    s_lshr_b32 s60, s58, 6
    s_min_u32 s60, s60, 9
    s_lshl_b32 s60, s60, 8
    s_add_u32 s60, s60, 720896
    v_and_b32 v12, 31, v1
    v_lshl_add_u32 v12, v12, 3, s60
    s_mul_i32 s60, s57, 5
    s_lshr_b32 s60, s60, 2
    s_lshl_b32 s60, s60, 8
    s_add_u32 s60, s60, 786432
    s_mul_i32 s61, s97, 13
    v_and_b32 v11, 31, v1
    v_min_u32 v11, 13, v11
    v_add_u32 v11, s61, v11
    v_and_b32 v29, 32, v1
    v_add_u32 v11, v11, v29
    v_lshl_add_u32 v11, v11, 3, s60
    s_add_u32 m0, s3, 32768
    s_nop 0
    s_waitcnt vmcnt(7)
    buffer_load_dwordx4 v120, s[8:11], s4 offen offset:0  lds
    s_waitcnt vmcnt(7)
    buffer_load_dwordx4 v121, s[8:11], s4 offen offset:1024  lds
    s_waitcnt vmcnt(7)
    buffer_load_dwordx4 v122, s[8:11], s4 offen offset:2048  lds
    s_waitcnt vmcnt(7)
    buffer_load_dwordx4 v123, s[8:11], s4 offen offset:3072  lds
    s_add_u32 m0, s3, 49152
    s_add_u32 s4, s4, 128
    s_waitcnt vmcnt(7)
    buffer_load_dwordx4 v124, s[24:27], s5 offen offset:0  lds
    s_waitcnt vmcnt(7)
    buffer_load_dwordx4 v125, s[24:27], s5 offen offset:1024  lds
    s_waitcnt vmcnt(7)
    buffer_load_dwordx4 v126, s[24:27], s5 offen offset:2048  lds
    s_waitcnt vmcnt(7)
    buffer_load_dwordx4 v127, s[24:27], s5 offen offset:3072  lds
    s_add_u32 s5, s5, 221184
    s_cmp_eq_u32 s4, 1280
    s_cselect_b32 s4, 0, s4
    s_cselect_b32 s5, 0, s5
    s_waitcnt vmcnt(8)
    s_barrier
    s_cmp_lg_u32 s90, 0
    s_cbranch_scc1 L_cs_24
    ds_read_b64_tr_b16 v[140:141], v132 offset:0
    ds_read_b64_tr_b16 v[142:143], v132 offset:1024
    ds_read_b64_tr_b16 v[144:145], v132 offset:8192
    ds_read_b64_tr_b16 v[146:147], v132 offset:9216
    ds_read_b64_tr_b16 v[148:149], v133 offset:0
    ds_read_b64_tr_b16 v[150:151], v133 offset:1024
    ds_read_b64_tr_b16 v[152:153], v133 offset:8192
    ds_read_b64_tr_b16 v[154:155], v133 offset:9216
L_cs_24:
    s_add_u32 m0, s3, 65536
    s_nop 0
    s_waitcnt vmcnt(7)
    buffer_load_dwordx4 v120, s[8:11], s4 offen offset:0  lds
    s_waitcnt vmcnt(7)
    buffer_load_dwordx4 v121, s[8:11], s4 offen offset:1024  lds
    s_waitcnt vmcnt(7)
    buffer_load_dwordx4 v122, s[8:11], s4 offen offset:2048  lds
    s_waitcnt vmcnt(7)
    buffer_load_dwordx4 v123, s[8:11], s4 offen offset:3072  lds
    s_add_u32 m0, s3, 81920
    s_add_u32 s4, s4, 128
    s_waitcnt vmcnt(7)
    buffer_load_dwordx4 v124, s[24:27], s5 offen offset:0  lds
    s_waitcnt vmcnt(7)
    buffer_load_dwordx4 v125, s[24:27], s5 offen offset:1024  lds
    s_waitcnt vmcnt(7)
    buffer_load_dwordx4 v126, s[24:27], s5 offen offset:2048  lds
    s_waitcnt vmcnt(7)
    buffer_load_dwordx4 v127, s[24:27], s5 offen offset:3072  lds
    s_add_u32 s5, s5, 221184
    s_cmp_eq_u32 s4, 1280
    s_cselect_b32 s4, 0, s4
    s_cselect_b32 s5, 0, s5
    s_mov_b32 m0, s12
    s_nop 0
    buffer_load_dwordx4 v2, s[20:23], s13 offen offset:0 nt lds
    buffer_load_dwordx4 v2, s[20:23], s13 offen offset:1024 nt lds
    buffer_load_dwordx4 v2, s[20:23], s13 offen offset:2048 nt lds
    buffer_load_dwordx4 v2, s[20:23], s13 offen offset:3072 nt lds
    buffer_load_ushort v34, v33, s[20:23], s96 offen
    buffer_load_ushort v35, v26, s[44:47], s40 offen
    s_mov_b32 m0, s17
    s_nop 0
    buffer_load_dwordx4 v180, s[28:31], s16 offen nt lds
    buffer_load_dwordx4 v181, s[28:31], s16 offen offset:1024 nt lds
    s_waitcnt lgkmcnt(0)
    s_waitcnt vmcnt(16)
    s_barrier
    s_cmp_lg_u32 s90, 1
    s_cbranch_scc1 L_cs_25
    ds_read_b64_tr_b16 v[140:141], v132 offset:0
    ds_read_b64_tr_b16 v[142:143], v132 offset:1024
    ds_read_b64_tr_b16 v[144:145], v132 offset:8192
    ds_read_b64_tr_b16 v[146:147], v132 offset:9216
    ds_read_b64_tr_b16 v[148:149], v133 offset:0
    ds_read_b64_tr_b16 v[150:151], v133 offset:1024
    ds_read_b64_tr_b16 v[152:153], v133 offset:8192
    ds_read_b64_tr_b16 v[154:155], v133 offset:9216
L_cs_25:
    s_add_u32 m0, s3, 98304
    s_nop 0
    buffer_load_dwordx4 v120, s[8:11], s4 offen offset:0  lds
    buffer_load_dwordx4 v121, s[8:11], s4 offen offset:1024  lds
    buffer_load_dwordx4 v122, s[8:11], s4 offen offset:2048  lds
    buffer_load_dwordx4 v123, s[8:11], s4 offen offset:3072  lds
    s_add_u32 m0, s3, 114688
    s_add_u32 s4, s4, 128
    buffer_load_dwordx4 v124, s[24:27], s5 offen offset:0  lds
    buffer_load_dwordx4 v125, s[24:27], s5 offen offset:1024  lds
    buffer_load_dwordx4 v126, s[24:27], s5 offen offset:2048  lds
    buffer_load_dwordx4 v127, s[24:27], s5 offen offset:3072  lds
    s_add_u32 s5, s5, 221184
    s_cmp_eq_u32 s4, 1280
    s_cselect_b32 s4, 0, s4
    s_cselect_b32 s5, 0, s5
    s_waitcnt lgkmcnt(0)
    s_waitcnt vmcnt(16)
    s_barrier
    s_cmp_lg_u32 s90, 2
    s_cbranch_scc1 L_cs_26
    ds_read_b64_tr_b16 v[140:141], v132 offset:0
    ds_read_b64_tr_b16 v[142:143], v132 offset:1024
    ds_read_b64_tr_b16 v[144:145], v132 offset:8192
    ds_read_b64_tr_b16 v[146:147], v132 offset:9216
    ds_read_b64_tr_b16 v[148:149], v133 offset:0
    ds_read_b64_tr_b16 v[150:151], v133 offset:1024
    ds_read_b64_tr_b16 v[152:153], v133 offset:8192
    ds_read_b64_tr_b16 v[154:155], v133 offset:9216
L_cs_26:
    s_add_u32 m0, s3, 0
    s_nop 0
    buffer_load_dwordx4 v120, s[8:11], s4 offen offset:0  lds
    buffer_load_dwordx4 v121, s[8:11], s4 offen offset:1024  lds
    buffer_load_dwordx4 v122, s[8:11], s4 offen offset:2048  lds
    buffer_load_dwordx4 v123, s[8:11], s4 offen offset:3072  lds
    s_add_u32 m0, s3, 16384
    s_add_u32 s4, s4, 128
    buffer_load_dwordx4 v124, s[24:27], s5 offen offset:0  lds
    buffer_load_dwordx4 v125, s[24:27], s5 offen offset:1024  lds
    buffer_load_dwordx4 v126, s[24:27], s5 offen offset:2048  lds
    buffer_load_dwordx4 v127, s[24:27], s5 offen offset:3072  lds
    s_add_u32 s5, s5, 221184
    s_cmp_eq_u32 s4, 1280
    s_cselect_b32 s4, 0, s4
    s_cselect_b32 s5, 0, s5
    s_waitcnt lgkmcnt(0)
    v_mfma_f32_16x16x32_bf16 v[164:167], v[140:143], v[136:139], 0
    v_mfma_f32_16x16x32_bf16 v[168:171], v[148:151], v[136:139], 0
    v_mfma_f32_16x16x32_bf16 v[164:167], v[144:147], v[136:139], v[164:167]
    v_mfma_f32_16x16x32_bf16 v[168:171], v[152:155], v[136:139], v[168:171]
    s_nop 7
    v_mov_b32 v176, v164
    v_mov_b32 v177, v165
    v_cmp_eq_u32 vcc, 1, v4
    s_nop 1
    v_cndmask_b32 v176, v176, v166, vcc
    v_cndmask_b32 v177, v177, v167, vcc
    v_cmp_eq_u32 vcc, 2, v4
    s_nop 1
    v_cndmask_b32 v176, v176, v168, vcc
    v_cndmask_b32 v177, v177, v169, vcc
    v_cmp_eq_u32 vcc, 3, v4
    s_nop 1
    v_cndmask_b32 v176, v176, v170, vcc
    v_cndmask_b32 v177, v177, v171, vcc
    s_mov_b32 exec_lo, 0x000f000f
    s_mov_b32 exec_hi, 0x000f000f
    buffer_store_dwordx4 v[176:179], v135, s[36:39], s88 offen sc1
    s_mov_b64 exec, -1
    s_waitcnt vmcnt(9)
    s_barrier
    ds_read_b64_tr_b16 v[184:185], v182 offset:0
    ds_read_b64_tr_b16 v[186:187], v182 offset:2048
    ds_read_b64_tr_b16 v[188:189], v182 offset:32
    ds_read_b64_tr_b16 v[190:191], v182 offset:2080
    s_add_u32 m0, s3, 32768
    s_nop 0
    buffer_load_dwordx4 v120, s[8:11], s4 offen offset:0  lds
    buffer_load_dwordx4 v121, s[8:11], s4 offen offset:1024  lds
    buffer_load_dwordx4 v122, s[8:11], s4 offen offset:2048  lds
    buffer_load_dwordx4 v123, s[8:11], s4 offen offset:3072  lds
    s_add_u32 m0, s3, 49152
    s_add_u32 s4, s4, 128
    buffer_load_dwordx4 v124, s[24:27], s5 offen offset:0  lds
    buffer_load_dwordx4 v125, s[24:27], s5 offen offset:1024  lds
    buffer_load_dwordx4 v126, s[24:27], s5 offen offset:2048  lds
    buffer_load_dwordx4 v127, s[24:27], s5 offen offset:3072  lds
    s_add_u32 s5, s5, 221184
    s_cmp_eq_u32 s4, 1280
    s_cselect_b32 s4, 0, s4
    s_cselect_b32 s5, 0, s5
    s_add_u32 m0, s3, 65536
    s_nop 0
    buffer_load_dwordx4 v120, s[8:11], s4 offen offset:0  lds
    buffer_load_dwordx4 v121, s[8:11], s4 offen offset:1024  lds
    buffer_load_dwordx4 v122, s[8:11], s4 offen offset:2048  lds
    buffer_load_dwordx4 v123, s[8:11], s4 offen offset:3072  lds
    s_waitcnt lgkmcnt(0)
    buffer_store_dwordx4 v[184:187], v2, s[36:39], s14 offen sc1
    buffer_store_dwordx4 v[188:191], v2, s[36:39], s15 offen sc1
    s_waitcnt vmcnt(15)
    s_barrier
    s_add_u32 m0, s3, 81920
    s_add_u32 s4, s4, 128
    buffer_load_dwordx4 v124, s[24:27], s5 offen offset:0  lds
    buffer_load_dwordx4 v125, s[24:27], s5 offen offset:1024  lds
    buffer_load_dwordx4 v126, s[24:27], s5 offen offset:2048  lds
    buffer_load_dwordx4 v127, s[24:27], s5 offen offset:3072  lds
    s_add_u32 s5, s5, 221184
    s_cmp_eq_u32 s4, 1280
    s_cselect_b32 s4, 0, s4
    s_cselect_b32 s5, 0, s5
    s_add_u32 m0, s3, 98304
    s_nop 0
    buffer_load_dwordx4 v120, s[8:11], s4 offen offset:0  lds
    buffer_load_dwordx4 v121, s[8:11], s4 offen offset:1024  lds
    buffer_load_dwordx4 v122, s[8:11], s4 offen offset:2048  lds
    buffer_load_dwordx4 v123, s[8:11], s4 offen offset:3072  lds
    s_waitcnt vmcnt(14)
    s_barrier
    s_add_u32 m0, s3, 114688
    s_add_u32 s4, s4, 128
    buffer_load_dwordx4 v124, s[24:27], s5 offen offset:0  lds
    buffer_load_dwordx4 v125, s[24:27], s5 offen offset:1024  lds
    buffer_load_dwordx4 v126, s[24:27], s5 offen offset:2048  lds
    buffer_load_dwordx4 v127, s[24:27], s5 offen offset:3072  lds
    s_add_u32 s5, s5, 221184
    s_cmp_eq_u32 s4, 1280
    s_cselect_b32 s4, 0, s4
    s_cselect_b32 s5, 0, s5
    s_add_u32 m0, s3, 0
    s_nop 0
    buffer_load_dwordx4 v120, s[8:11], s4 offen offset:0  lds
    buffer_load_dwordx4 v121, s[8:11], s4 offen offset:1024  lds
    buffer_load_dwordx4 v122, s[8:11], s4 offen offset:2048  lds
    buffer_load_dwordx4 v123, s[8:11], s4 offen offset:3072  lds
    s_add_u32 m0, s3, 16384
    s_add_u32 s4, s4, 128
    buffer_load_dwordx4 v124, s[24:27], s5 offen offset:0  lds
    buffer_load_dwordx4 v125, s[24:27], s5 offen offset:1024  lds
    buffer_load_dwordx4 v126, s[24:27], s5 offen offset:2048  lds
    buffer_load_dwordx4 v127, s[24:27], s5 offen offset:3072  lds
    s_add_u32 s5, s5, 221184
    s_cmp_eq_u32 s4, 1280
    s_cselect_b32 s4, 0, s4
    s_cselect_b32 s5, 0, s5
    s_waitcnt vmcnt(16)
    s_barrier
    s_add_u32 m0, s3, 32768
    s_nop 0
    buffer_load_dwordx4 v120, s[8:11], s4 offen offset:0  lds
    buffer_load_dwordx4 v121, s[8:11], s4 offen offset:1024  lds
    buffer_load_dwordx4 v122, s[8:11], s4 offen offset:2048  lds
    buffer_load_dwordx4 v123, s[8:11], s4 offen offset:3072  lds
    s_add_u32 m0, s3, 49152
    s_add_u32 s4, s4, 128
    buffer_load_dwordx4 v124, s[24:27], s5 offen offset:0  lds
    buffer_load_dwordx4 v125, s[24:27], s5 offen offset:1024  lds
    buffer_load_dwordx4 v126, s[24:27], s5 offen offset:2048  lds
    buffer_load_dwordx4 v127, s[24:27], s5 offen offset:3072  lds
    s_add_u32 s5, s5, 221184
    s_cmp_eq_u32 s4, 1280
    s_cselect_b32 s4, 0, s4
    s_cselect_b32 s5, 0, s5
    s_cmp_eq_u32 s52, 0
    s_mov_b64 exec, 1
    s_cselect_b32 s60, s89, 0x80000000
    buffer_store_dwordx2 v[24:25], v26, s[36:39], s60 offen sc1
    s_mov_b64 exec, -1
    s_waitcnt vmcnt(16)
    s_barrier
    s_and_b32 s62, s94, 0
    buffer_load_dwordx4 v[88:91], v10, s[36:39], s62 offen sc1
    s_and_b32 s62, s94, 27648
    buffer_load_dwordx4 v[92:95], v10, s[36:39], s62 offen sc1
    s_and_b32 s62, s94, 55296
    buffer_load_dwordx4 v[96:99], v10, s[36:39], s62 offen sc1
    s_and_b32 s62, s94, 82944
    buffer_load_dwordx4 v[100:103], v10, s[36:39], s62 offen sc1
    s_and_b32 s62, s94, 110592
    buffer_load_dwordx4 v[104:107], v10, s[36:39], s62 offen sc1
    s_cmp_eq_u32 s52, 0
    s_cselect_b32 s60, 0, 0x80000000
    v_mov_b32 v226, s48
    v_mov_b32 v227, s49
    s_mov_b32 exec_lo, 4294967295
    s_mov_b32 exec_hi, 0
    v_mov_b32 v226, 0
    v_mov_b32 v227, 0
    buffer_atomic_or_x2 v[226:227], v12, s[36:39], s60 offen sc0 sc1
    s_mov_b64 exec, -1
    s_waitcnt vmcnt(5)
    s_barrier
    s_mov_b32 s59, 20000
    s_waitcnt vmcnt(0)
L_chk_gr_27:
    v_cmp_ne_u64 s[60:61], s[48:49], v[90:91]
    v_cmp_ne_u64 vcc, s[48:49], v[94:95]
    s_or_b64 s[60:61], s[60:61], vcc
    v_cmp_ne_u64 vcc, s[48:49], v[98:99]
    s_or_b64 s[60:61], s[60:61], vcc
    v_cmp_ne_u64 vcc, s[48:49], v[102:103]
    s_or_b64 s[60:61], s[60:61], vcc
    v_cmp_ne_u64 vcc, s[48:49], v[106:107]
    s_or_b64 s[60:61], s[60:61], vcc
    s_cmp_eq_u64 s[60:61], 0
    s_cbranch_scc1 L_chkok_gr_28
    s_sub_u32 s59, s59, 1
    s_cbranch_scc1 L_chkok_gr_28
    s_sleep 6
    s_and_b32 s62, s94, 0
    buffer_load_dwordx4 v[88:91], v10, s[36:39], s62 offen sc1
    s_and_b32 s62, s94, 27648
    buffer_load_dwordx4 v[92:95], v10, s[36:39], s62 offen sc1
    s_and_b32 s62, s94, 55296
    buffer_load_dwordx4 v[96:99], v10, s[36:39], s62 offen sc1
    s_and_b32 s62, s94, 82944
    buffer_load_dwordx4 v[100:103], v10, s[36:39], s62 offen sc1
    s_and_b32 s62, s94, 110592
    buffer_load_dwordx4 v[104:107], v10, s[36:39], s62 offen sc1
    s_waitcnt vmcnt(0)
    s_branch L_chk_gr_27
L_chkok_gr_28:
    s_cmp_lg_u32 s52, 0
    s_cbranch_scc1 L_hc_29
    v_lshlrev_b32 v5, 2, v1
    v_add_u32 v5, 158720, v5
    ds_write2st64_b32 v5, v88, v92 offset0:0 offset1:1
    s_branch L_hd_30
L_hc_29:
    v_add_f32 v88, v88, v92
    v_add_f32 v89, v89, v93
    v_add_f32 v88, v88, v96
    v_add_f32 v89, v89, v97
    v_add_f32 v88, v88, v100
    v_add_f32 v89, v89, v101
    v_add_f32 v88, v88, v104
    v_add_f32 v89, v89, v105
    v_mov_b32 v90, v88
    v_mov_b32 v91, v89
    s_lshl_b32 s60, s93, 8
    s_add_u32 s60, s60, 158976
    v_lshl_add_u32 v5, v13, 3, s60
    v_permlane32_swap_b32 v88, v90
    v_permlane32_swap_b32 v89, v91
    s_nop 1
    v_add_f32 v88, v88, v90
    v_add_f32 v89, v89, v91
    ds_write_b64 v5, v[88:89]
L_hd_30:
    s_add_u32 s99, s99, 1
    v_mov_b32 v29, s99
    ds_write_b32 v27, v29
    s_cmp_lg_u32 s52, 0
    s_cbranch_scc1 L_o0_31
    s_waitcnt vmcnt(0)
    v_cmp_ne_u64 vcc, s[48:49], v[226:227]
    s_cbranch_vccz L_polld_kvg_33
    s_mov_b32 s59, 20000
L_poll_kvg_32:
    s_sleep 6
    v_mov_b32 v226, s48
    v_mov_b32 v227, s49
    s_mov_b32 exec_lo, 4294967295
    s_mov_b32 exec_hi, 0
    v_mov_b32 v226, 0
    v_mov_b32 v227, 0
    buffer_atomic_or_x2 v[226:227], v12, s[36:39], 0 offen sc0 sc1
    s_mov_b64 exec, -1
    s_waitcnt vmcnt(0)
    v_cmp_ne_u64 vcc, s[48:49], v[226:227]
    s_cbranch_vccz L_polld_kvg_33
    s_sub_u32 s59, s59, 1
    s_cbranch_scc0 L_poll_kvg_32
L_polld_kvg_33:
L_o0_31:
    s_cmp_eq_u32 s52, 3
    s_cselect_b32 s60, 0, 0x80000000
    v_mov_b32 v228, s48
    v_mov_b32 v229, s49
    s_mov_b32 exec_lo, 16383
    s_mov_b32 exec_hi, 16383
    v_mov_b32 v228, 0
    v_mov_b32 v229, 0
    buffer_atomic_or_x2 v[228:229], v11, s[36:39], s60 offen sc0 sc1
    s_mov_b64 exec, -1
    s_add_u32 s99, s99, 1
    v_mov_b32 v29, s99
    ds_write_b32 v27, v29
    v_mov_b32 v4, 163792
    s_mov_b32 s59, 1000000
L_lw_kvok_34:
    ds_read_b32 v29, v4
    s_waitcnt lgkmcnt(0)
    v_cmp_gt_u32 vcc, 2, v29
    s_cbranch_vccz L_lwd_kvok_35
    s_sleep 1
    s_sub_u32 s59, s59, 1
    s_cbranch_scc0 L_lw_kvok_34
L_lwd_kvok_35:
    s_add_u32 s60, s96, 1048576
    s_mov_b32 m0, s92
    v_mov_b32 v14, 0
    v_mov_b32 v15, 0
    v_lshlrev_b32 v8, 3, v1
    v_add_u32 v8, s92, v8
    ds_write_b64 v8, v[14:15] offset:4096
    buffer_load_dwordx4 v2, s[36:39], s60 offen offset:0 sc1 lds
    buffer_load_dwordx4 v2, s[36:39], s60 offen offset:1024 sc1 lds
    buffer_load_dwordx4 v2, s[36:39], s60 offen offset:2048 sc1 lds
    buffer_load_dwordx4 v2, s[36:39], s60 offen offset:3072 sc1 lds
    s_cmp_lg_u32 s52, 3
    s_cbranch_scc1 L_nw2
    s_waitcnt vmcnt(4)
    v_cmp_ne_u64 vcc, s[48:49], v[228:229]
    s_cbranch_vccz L_polld_w2_37
    s_mov_b32 s59, 20000
L_poll_w2_36:
    s_sleep 6
    v_mov_b32 v228, s48
    v_mov_b32 v229, s49
    s_mov_b32 exec_lo, 16383
    s_mov_b32 exec_hi, 16383
    v_mov_b32 v228, 0
    v_mov_b32 v229, 0
    buffer_atomic_or_x2 v[228:229], v11, s[36:39], 0 offen sc0 sc1
    s_mov_b64 exec, -1
    s_waitcnt vmcnt(0)
    v_cmp_ne_u64 vcc, s[48:49], v[228:229]
    s_cbranch_vccz L_polld_w2_37
    s_sub_u32 s59, s59, 1
    s_cbranch_scc0 L_poll_w2_36
L_polld_w2_37:
    v_mov_b32 v4, 163824
    v_mov_b32 v30, 1
    ds_max_u32 v4, v30
L_nw2:
    s_sub_u32 s60, s18, s95
    v_and_b32 v19, 1, v6
    v_mul_lo_u32 v19, v19, s60
    v_lshrrev_b32 v9, 1, v6
    v_mul_u32_u24 v9, 4224, v9
    v_add3_u32 v9, v9, v19, s95
    v_lshl_add_u32 v9, v7, 1, v9
    s_waitcnt vmcnt(63)
    ds_write_b16 v9, v34
    ds_read_b128 v[64:67], v16 offset:32
    ds_read_b32 v68, v16 offset:48
    ds_read_b128 v[72:75], v16 offset:1056
    ds_read_b32 v76, v16 offset:1072
    ds_read_b128 v[80:83], v16 offset:2080
    ds_read_b32 v84, v16 offset:2096
    ds_read_b128 v[88:91], v16 offset:3104
    ds_read_b32 v92, v16 offset:3120
    v_add_u32 v8, 1, v7
    v_and_b32 v8, 3, v8
    v_lshl_add_u32 v17, v6, 3, v7
    v_sub_u32 v17, v17, v8
    v_lshlrev_b32 v17, 1, v17
    s_sub_u32 s60, s18, s95
    v_and_b32 v19, 1, v8
    v_mul_lo_u32 v19, v19, s60
    v_lshrrev_b32 v9, 1, v8
    v_mul_u32_u24 v9, 4224, v9
    v_add3_u32 v9, v9, v19, s95
    v_add_u32 v15, s60, v16
    s_lshl_b32 s61, s6, 8
    v_add3_u32 v17, v17, v9, s61
    s_add_u32 s61, s61, s92
    v_add_u32 v17, 2, v17
    v_lshlrev_b32 v18, 5, v7
    v_sub_u32 v18, 480, v18
    v_lshl_add_u32 v18, v6, 4, v18
    v_add_u32 v18, s61, v18
    v_lshl_add_u32 v8, v6, 3, v7
    v_sub_u32 v8, 15, v8
    v_and_b32 v19, 1, v8
    v_lshlrev_b32 v19, 4, v19
    v_lshlrev_b32 v19, v19, v35
    v_ashrrev_i32 v8, 1, v8
    v_cmp_eq_u32 vcc, 0, v8
    s_nop 1
    v_cndmask_b32 v20, 0, v19, vcc
    v_cmp_eq_u32 vcc, 1, v8
    s_nop 1
    v_cndmask_b32 v21, 0, v19, vcc
    v_cmp_eq_u32 vcc, 2, v8
    s_nop 1
    v_cndmask_b32 v22, 0, v19, vcc
    v_cmp_eq_u32 vcc, 3, v8
    s_nop 1
    v_cndmask_b32 v23, 0, v19, vcc
    s_waitcnt lgkmcnt(6)
    v_alignbit_b32 v96, v65, v64, 16
    v_alignbit_b32 v97, v66, v65, 16
    v_alignbit_b32 v98, v67, v66, 16
    v_alignbit_b32 v99, v68, v67, 16
    ds_write_b128 v15, v[96:99] offset:32
    s_waitcnt lgkmcnt(5)
    v_alignbit_b32 v100, v73, v72, 16
    v_alignbit_b32 v101, v74, v73, 16
    v_alignbit_b32 v102, v75, v74, 16
    v_alignbit_b32 v103, v76, v75, 16
    ds_write_b128 v15, v[100:103] offset:1056
    s_waitcnt lgkmcnt(4)
    v_alignbit_b32 v104, v81, v80, 16
    v_alignbit_b32 v105, v82, v81, 16
    v_alignbit_b32 v106, v83, v82, 16
    v_alignbit_b32 v107, v84, v83, 16
    ds_write_b128 v15, v[104:107] offset:2080
    s_waitcnt lgkmcnt(3)
    v_alignbit_b32 v108, v89, v88, 16
    v_alignbit_b32 v109, v90, v89, 16
    v_alignbit_b32 v110, v91, v90, 16
    v_alignbit_b32 v111, v92, v91, 16
    ds_write_b128 v15, v[108:111] offset:3104
    s_add_u32 s99, s99, 1
    v_mov_b32 v29, s99
    s_waitcnt lgkmcnt(0)
    ds_write_b32 v27, v29
    s_mov_b32 s59, 1000000
L_ps_38:
    ds_read_b32 v29, v28
    s_waitcnt lgkmcnt(0)
    v_cmp_gt_u32 vcc, s99, v29
    s_cbranch_vccz L_psd_39
    s_sleep 1
    s_sub_u32 s59, s59, 1
    s_cbranch_scc0 L_ps_38
L_psd_39:
    s_waitcnt vmcnt(0)
    v_add_u32 v14, 16, v27
    s_mov_b32 s59, 1000000
L_lw_epi_40:
    ds_read_b32 v29, v14
    s_waitcnt lgkmcnt(0)
    v_cmp_gt_u32 vcc, 1, v29
    s_cbranch_vccz L_lwd_epi_41
    s_sleep 1
    s_sub_u32 s59, s59, 1
    s_cbranch_scc0 L_lw_epi_40
L_lwd_epi_41:
L_lconv:
    s_setprio 2
    ds_read_b128 v[64:67], v18 offset:3584
    ds_read_b128 v[68:71], v18 offset:3072
    ds_read_b128 v[72:75], v18 offset:2560
    ds_read_b128 v[76:79], v18 offset:2048
    ds_read_b128 v[80:83], v18 offset:1536
    ds_read_b128 v[84:87], v18 offset:1024
    ds_read_b128 v[88:91], v18 offset:512
    ds_read_b128 v[92:95], v18 offset:0
    ds_read_b64 v[96:97], v17 offset:0
    ds_read_b64 v[98:99], v17 offset:8
    ds_read_b64 v[100:101], v17 offset:512
    ds_read_b64 v[102:103], v17 offset:520
    s_waitcnt lgkmcnt(11)
    v_mfma_f32_16x16x32_bf16 v[32:35], v[20:23], v[64:67], 0
    ds_read_b64 v[104:105], v17 offset:1024
    ds_read_b64 v[106:107], v17 offset:1032
    s_waitcnt lgkmcnt(12)
    v_mfma_f32_16x16x32_bf16 v[36:39], v[20:23], v[68:71], 0
    ds_read_b64 v[108:109], v17 offset:1536
    ds_read_b64 v[110:111], v17 offset:1544
    s_waitcnt lgkmcnt(13)
    v_mfma_f32_16x16x32_bf16 v[40:43], v[20:23], v[72:75], 0
    ds_read_b64 v[112:113], v17 offset:2048
    ds_read_b64 v[114:115], v17 offset:2056
    s_waitcnt lgkmcnt(14)
    v_mfma_f32_16x16x32_bf16 v[44:47], v[20:23], v[76:79], 0
    ds_read_b64 v[116:117], v17 offset:2560
    ds_read_b64 v[118:119], v17 offset:2568
    s_waitcnt lgkmcnt(15)
    v_mfma_f32_16x16x32_bf16 v[48:51], v[20:23], v[80:83], 0
    ds_read_b64 v[120:121], v17 offset:3072
    ds_read_b64 v[122:123], v17 offset:3080
    s_waitcnt lgkmcnt(15)
    v_mfma_f32_16x16x32_bf16 v[52:55], v[20:23], v[84:87], 0
    ds_read_b64 v[124:125], v17 offset:3584
    ds_read_b64 v[126:127], v17 offset:3592
    v_mfma_f32_16x16x32_bf16 v[56:59], v[20:23], v[88:91], 0
    ds_read_b64 v[128:129], v17 offset:3648
    ds_read_b64 v[130:131], v17 offset:3656
    s_waitcnt lgkmcnt(15)
    v_mfma_f32_16x16x32_bf16 v[60:63], v[20:23], v[92:95], 0
    ds_read_b128 v[132:135], v18 offset:3648
    v_mfma_f32_16x16x32_bf16 v[32:35], v[96:99], v[64:67], v[32:35]
    ds_read_b64 v[136:137], v17 offset:3136
    ds_read_b64 v[138:139], v17 offset:3144
    v_mfma_f32_16x16x32_bf16 v[36:39], v[96:99], v[68:71], v[36:39]
    ds_read_b128 v[140:143], v18 offset:3136
    v_mfma_f32_16x16x32_bf16 v[40:43], v[96:99], v[72:75], v[40:43]
    ds_read_b64 v[144:145], v17 offset:2624
    ds_read_b64 v[146:147], v17 offset:2632
    v_mfma_f32_16x16x32_bf16 v[44:47], v[96:99], v[76:79], v[44:47]
    ds_read_b128 v[148:151], v18 offset:2624
    v_mfma_f32_16x16x32_bf16 v[48:51], v[96:99], v[80:83], v[48:51]
    ds_read_b64 v[152:153], v17 offset:2112
    ds_read_b64 v[154:155], v17 offset:2120
    v_mfma_f32_16x16x32_bf16 v[52:55], v[96:99], v[84:87], v[52:55]
    ds_read_b128 v[156:159], v18 offset:2112
    v_mfma_f32_16x16x32_bf16 v[56:59], v[96:99], v[88:91], v[56:59]
    ds_read_b64 v[160:161], v17 offset:1600
    ds_read_b64 v[162:163], v17 offset:1608
    v_mfma_f32_16x16x32_bf16 v[60:63], v[96:99], v[92:95], v[60:63]
    ds_read_b128 v[164:167], v18 offset:1600
    s_waitcnt lgkmcnt(15)
    v_mfma_f32_16x16x32_bf16 v[36:39], v[100:103], v[64:67], v[36:39]
    ds_read_b64 v[168:169], v17 offset:1088
    ds_read_b64 v[170:171], v17 offset:1096
    v_mfma_f32_16x16x32_bf16 v[40:43], v[100:103], v[68:71], v[40:43]
    ds_read_b128 v[172:175], v18 offset:1088
    v_mfma_f32_16x16x32_bf16 v[44:47], v[100:103], v[72:75], v[44:47]
    ds_read_b64 v[176:177], v17 offset:576
    ds_read_b64 v[178:179], v17 offset:584
    v_mfma_f32_16x16x32_bf16 v[48:51], v[100:103], v[76:79], v[48:51]
    ds_read_b128 v[180:183], v18 offset:576
    v_mfma_f32_16x16x32_bf16 v[52:55], v[100:103], v[80:83], v[52:55]
    ds_read_b64 v[184:185], v17 offset:64
    ds_read_b64 v[186:187], v17 offset:72
    v_mfma_f32_16x16x32_bf16 v[56:59], v[100:103], v[84:87], v[56:59]
    ds_read_b128 v[188:191], v18 offset:64
    v_mfma_f32_16x16x32_bf16 v[60:63], v[100:103], v[88:91], v[60:63]
    ds_read_b64 v[192:193], v17 offset:128
    ds_read_b64 v[194:195], v17 offset:136
    v_mfma_f32_16x16x32_bf16 v[40:43], v[104:107], v[64:67], v[40:43]
    ds_read_b128 v[196:199], v18 offset:3712
    v_mfma_f32_16x16x32_bf16 v[44:47], v[104:107], v[68:71], v[44:47]
    ds_read_b128 v[200:203], v18 offset:3200
    v_mfma_f32_16x16x32_bf16 v[48:51], v[104:107], v[72:75], v[48:51]
    ds_read_b128 v[204:207], v18 offset:2688
    v_mfma_f32_16x16x32_bf16 v[52:55], v[104:107], v[76:79], v[52:55]
    ds_read_b128 v[208:211], v18 offset:2176
    v_mfma_f32_16x16x32_bf16 v[56:59], v[104:107], v[80:83], v[56:59]
    ds_read_b128 v[212:215], v18 offset:1664
    v_mfma_f32_16x16x32_bf16 v[60:63], v[104:107], v[84:87], v[60:63]
    ds_read_b128 v[216:219], v18 offset:1152
    v_mfma_f32_16x16x32_bf16 v[44:47], v[108:111], v[64:67], v[44:47]
    ds_read_b128 v[220:223], v18 offset:640
    v_mfma_f32_16x16x32_bf16 v[48:51], v[108:111], v[68:71], v[48:51]
    ds_read_b128 v[96:99], v18 offset:128
    v_mfma_f32_16x16x32_bf16 v[52:55], v[108:111], v[72:75], v[52:55]
    ds_read_b64 v[92:93], v17 offset:640
    ds_read_b64 v[94:95], v17 offset:648
    v_mfma_f32_16x16x32_bf16 v[56:59], v[108:111], v[76:79], v[56:59]
    ds_read_b64 v[100:101], v17 offset:1152
    ds_read_b64 v[102:103], v17 offset:1160
    v_mfma_f32_16x16x32_bf16 v[60:63], v[108:111], v[80:83], v[60:63]
    ds_read_b64 v[88:89], v17 offset:1664
    ds_read_b64 v[90:91], v17 offset:1672
    v_mfma_f32_16x16x32_bf16 v[48:51], v[112:115], v[64:67], v[48:51]
    ds_read_b64 v[104:105], v17 offset:2176
    ds_read_b64 v[106:107], v17 offset:2184
    v_mfma_f32_16x16x32_bf16 v[52:55], v[112:115], v[68:71], v[52:55]
    ds_read_b64 v[84:85], v17 offset:2688
    ds_read_b64 v[86:87], v17 offset:2696
    v_mfma_f32_16x16x32_bf16 v[56:59], v[112:115], v[72:75], v[56:59]
    ds_read_b64 v[108:109], v17 offset:3200
    ds_read_b64 v[110:111], v17 offset:3208
    v_mfma_f32_16x16x32_bf16 v[60:63], v[112:115], v[76:79], v[60:63]
    ds_read_b64 v[80:81], v17 offset:3712
    ds_read_b64 v[82:83], v17 offset:3720
    v_mfma_f32_16x16x32_bf16 v[52:55], v[116:119], v[64:67], v[52:55]
    ds_read_b64 v[112:113], v17 offset:3776
    ds_read_b64 v[114:115], v17 offset:3784
    v_mfma_f32_16x16x32_bf16 v[56:59], v[116:119], v[68:71], v[56:59]
    ds_read_b128 v[76:79], v18 offset:3776
    v_mfma_f32_16x16x32_bf16 v[60:63], v[116:119], v[72:75], v[60:63]
    ds_read_b64 v[116:117], v17 offset:3264
    ds_read_b64 v[118:119], v17 offset:3272
    v_mfma_f32_16x16x32_bf16 v[56:59], v[120:123], v[64:67], v[56:59]
    ds_read_b128 v[72:75], v18 offset:3264
    v_mfma_f32_16x16x32_bf16 v[60:63], v[120:123], v[68:71], v[60:63]
    ds_read_b64 v[120:121], v17 offset:2752
    ds_read_b64 v[122:123], v17 offset:2760
    v_mfma_f32_16x16x32_bf16 v[60:63], v[124:127], v[64:67], v[60:63]
    ds_read_b128 v[68:71], v18 offset:2752
    s_waitcnt lgkmcnt(15)
    v_mfma_f32_16x16x32_bf16 v[60:63], v[128:131], v[132:135], v[60:63]
    ds_read_b64 v[124:125], v17 offset:2240
    ds_read_b64 v[126:127], v17 offset:2248
    v_mfma_f32_16x16x32_bf16 v[56:59], v[136:139], v[132:135], v[56:59]
    ds_read_b128 v[64:67], v18 offset:2240
    v_mfma_f32_16x16x32_bf16 v[60:63], v[136:139], v[140:143], v[60:63]
    ds_read_b64 v[128:129], v17 offset:1728
    ds_read_b64 v[130:131], v17 offset:1736
    v_mfma_f32_16x16x32_bf16 v[52:55], v[144:147], v[132:135], v[52:55]
    ds_read_b128 v[136:139], v18 offset:1728
    v_mfma_f32_16x16x32_bf16 v[56:59], v[144:147], v[140:143], v[56:59]
    v_mfma_f32_16x16x32_bf16 v[60:63], v[144:147], v[148:151], v[60:63]
    ds_read_b64 v[144:145], v17 offset:1216
    ds_read_b64 v[146:147], v17 offset:1224
    v_mfma_f32_16x16x32_bf16 v[48:51], v[152:155], v[132:135], v[48:51]
    v_mfma_f32_16x16x32_bf16 v[52:55], v[152:155], v[140:143], v[52:55]
    v_mfma_f32_16x16x32_bf16 v[56:59], v[152:155], v[148:151], v[56:59]
    v_mfma_f32_16x16x32_bf16 v[60:63], v[152:155], v[156:159], v[60:63]
    ds_read_b128 v[152:155], v18 offset:1216
    v_mfma_f32_16x16x32_bf16 v[44:47], v[160:163], v[132:135], v[44:47]
    v_mfma_f32_16x16x32_bf16 v[48:51], v[160:163], v[140:143], v[48:51]
    v_mfma_f32_16x16x32_bf16 v[52:55], v[160:163], v[148:151], v[52:55]
    v_mfma_f32_16x16x32_bf16 v[56:59], v[160:163], v[156:159], v[56:59]
    v_mfma_f32_16x16x32_bf16 v[60:63], v[160:163], v[164:167], v[60:63]
    ds_read_b64 v[160:161], v17 offset:704
    ds_read_b64 v[162:163], v17 offset:712
    v_mfma_f32_16x16x32_bf16 v[40:43], v[168:171], v[132:135], v[40:43]
    v_mfma_f32_16x16x32_bf16 v[44:47], v[168:171], v[140:143], v[44:47]
    v_mfma_f32_16x16x32_bf16 v[48:51], v[168:171], v[148:151], v[48:51]
    v_mfma_f32_16x16x32_bf16 v[52:55], v[168:171], v[156:159], v[52:55]
    v_mfma_f32_16x16x32_bf16 v[56:59], v[168:171], v[164:167], v[56:59]
    v_mfma_f32_16x16x32_bf16 v[60:63], v[168:171], v[172:175], v[60:63]
    ds_read_b128 v[168:171], v18 offset:704
    v_mfma_f32_16x16x32_bf16 v[36:39], v[176:179], v[132:135], v[36:39]
    v_mfma_f32_16x16x32_bf16 v[40:43], v[176:179], v[140:143], v[40:43]
    v_mfma_f32_16x16x32_bf16 v[44:47], v[176:179], v[148:151], v[44:47]
    v_mfma_f32_16x16x32_bf16 v[48:51], v[176:179], v[156:159], v[48:51]
    v_mfma_f32_16x16x32_bf16 v[52:55], v[176:179], v[164:167], v[52:55]
    v_mfma_f32_16x16x32_bf16 v[56:59], v[176:179], v[172:175], v[56:59]
    v_mfma_f32_16x16x32_bf16 v[60:63], v[176:179], v[180:183], v[60:63]
    ds_read_b64 v[176:177], v17 offset:192
    ds_read_b64 v[178:179], v17 offset:200
    v_mfma_f32_16x16x32_bf16 v[32:35], v[184:187], v[132:135], v[32:35]
    ds_read_b128 v[132:135], v18 offset:192
    v_mfma_f32_16x16x32_bf16 v[36:39], v[184:187], v[140:143], v[36:39]
    v_mfma_f32_16x16x32_bf16 v[40:43], v[184:187], v[148:151], v[40:43]
    v_mfma_f32_16x16x32_bf16 v[44:47], v[184:187], v[156:159], v[44:47]
    v_mfma_f32_16x16x32_bf16 v[48:51], v[184:187], v[164:167], v[48:51]
    v_mfma_f32_16x16x32_bf16 v[52:55], v[184:187], v[172:175], v[52:55]
    v_mfma_f32_16x16x32_bf16 v[56:59], v[184:187], v[180:183], v[56:59]
    v_mfma_f32_16x16x32_bf16 v[60:63], v[184:187], v[188:191], v[60:63]
    v_mfma_f32_16x16x32_bf16 v[32:35], v[192:195], v[196:199], v[32:35]
    v_mfma_f32_16x16x32_bf16 v[36:39], v[192:195], v[200:203], v[36:39]
    v_mfma_f32_16x16x32_bf16 v[40:43], v[192:195], v[204:207], v[40:43]
    v_mfma_f32_16x16x32_bf16 v[44:47], v[192:195], v[208:211], v[44:47]
    v_mfma_f32_16x16x32_bf16 v[48:51], v[192:195], v[212:215], v[48:51]
    v_mfma_f32_16x16x32_bf16 v[52:55], v[192:195], v[216:219], v[52:55]
    v_mfma_f32_16x16x32_bf16 v[56:59], v[192:195], v[220:223], v[56:59]
    v_mfma_f32_16x16x32_bf16 v[60:63], v[192:195], v[96:99], v[60:63]
    v_mfma_f32_16x16x32_bf16 v[36:39], v[92:95], v[196:199], v[36:39]
    v_mfma_f32_16x16x32_bf16 v[40:43], v[92:95], v[200:203], v[40:43]
    v_mfma_f32_16x16x32_bf16 v[44:47], v[92:95], v[204:207], v[44:47]
    v_mfma_f32_16x16x32_bf16 v[48:51], v[92:95], v[208:211], v[48:51]
    v_mfma_f32_16x16x32_bf16 v[52:55], v[92:95], v[212:215], v[52:55]
    v_mfma_f32_16x16x32_bf16 v[56:59], v[92:95], v[216:219], v[56:59]
    v_mfma_f32_16x16x32_bf16 v[60:63], v[92:95], v[220:223], v[60:63]
    v_mfma_f32_16x16x32_bf16 v[40:43], v[100:103], v[196:199], v[40:43]
    v_mfma_f32_16x16x32_bf16 v[44:47], v[100:103], v[200:203], v[44:47]
    v_mfma_f32_16x16x32_bf16 v[48:51], v[100:103], v[204:207], v[48:51]
    v_mfma_f32_16x16x32_bf16 v[52:55], v[100:103], v[208:211], v[52:55]
    v_mfma_f32_16x16x32_bf16 v[56:59], v[100:103], v[212:215], v[56:59]
    v_mfma_f32_16x16x32_bf16 v[60:63], v[100:103], v[216:219], v[60:63]
    v_mfma_f32_16x16x32_bf16 v[44:47], v[88:91], v[196:199], v[44:47]
    v_mfma_f32_16x16x32_bf16 v[48:51], v[88:91], v[200:203], v[48:51]
    v_mfma_f32_16x16x32_bf16 v[52:55], v[88:91], v[204:207], v[52:55]
    v_mfma_f32_16x16x32_bf16 v[56:59], v[88:91], v[208:211], v[56:59]
    v_mfma_f32_16x16x32_bf16 v[60:63], v[88:91], v[212:215], v[60:63]
    v_mfma_f32_16x16x32_bf16 v[48:51], v[104:107], v[196:199], v[48:51]
    v_mfma_f32_16x16x32_bf16 v[52:55], v[104:107], v[200:203], v[52:55]
    v_mfma_f32_16x16x32_bf16 v[56:59], v[104:107], v[204:207], v[56:59]
    v_mfma_f32_16x16x32_bf16 v[60:63], v[104:107], v[208:211], v[60:63]
    s_waitcnt lgkmcnt(15)
    v_mfma_f32_16x16x32_bf16 v[52:55], v[84:87], v[196:199], v[52:55]
    v_mfma_f32_16x16x32_bf16 v[56:59], v[84:87], v[200:203], v[56:59]
    v_mfma_f32_16x16x32_bf16 v[60:63], v[84:87], v[204:207], v[60:63]
    v_mfma_f32_16x16x32_bf16 v[56:59], v[108:111], v[196:199], v[56:59]
    v_mfma_f32_16x16x32_bf16 v[60:63], v[108:111], v[200:203], v[60:63]
    v_mfma_f32_16x16x32_bf16 v[60:63], v[80:83], v[196:199], v[60:63]
    v_mfma_f32_16x16x32_bf16 v[60:63], v[112:115], v[76:79], v[60:63]
    v_mfma_f32_16x16x32_bf16 v[56:59], v[116:119], v[76:79], v[56:59]
    v_mfma_f32_16x16x32_bf16 v[60:63], v[116:119], v[72:75], v[60:63]
    v_mfma_f32_16x16x32_bf16 v[52:55], v[120:123], v[76:79], v[52:55]
    v_mfma_f32_16x16x32_bf16 v[56:59], v[120:123], v[72:75], v[56:59]
    v_mfma_f32_16x16x32_bf16 v[60:63], v[120:123], v[68:71], v[60:63]
    s_waitcnt lgkmcnt(13)
    v_mfma_f32_16x16x32_bf16 v[48:51], v[124:127], v[76:79], v[48:51]
    v_mfma_f32_16x16x32_bf16 v[52:55], v[124:127], v[72:75], v[52:55]
    v_mfma_f32_16x16x32_bf16 v[56:59], v[124:127], v[68:71], v[56:59]
    s_waitcnt lgkmcnt(12)
    v_mfma_f32_16x16x32_bf16 v[60:63], v[124:127], v[64:67], v[60:63]
    s_waitcnt lgkmcnt(10)
    v_mfma_f32_16x16x32_bf16 v[44:47], v[128:131], v[76:79], v[44:47]
    v_mfma_f32_16x16x32_bf16 v[48:51], v[128:131], v[72:75], v[48:51]
    v_mfma_f32_16x16x32_bf16 v[52:55], v[128:131], v[68:71], v[52:55]
    v_mfma_f32_16x16x32_bf16 v[56:59], v[128:131], v[64:67], v[56:59]
    s_waitcnt lgkmcnt(9)
    v_mfma_f32_16x16x32_bf16 v[60:63], v[128:131], v[136:139], v[60:63]
    s_waitcnt lgkmcnt(7)
    v_mfma_f32_16x16x32_bf16 v[40:43], v[144:147], v[76:79], v[40:43]
    v_mfma_f32_16x16x32_bf16 v[44:47], v[144:147], v[72:75], v[44:47]
    v_mfma_f32_16x16x32_bf16 v[48:51], v[144:147], v[68:71], v[48:51]
    v_mfma_f32_16x16x32_bf16 v[52:55], v[144:147], v[64:67], v[52:55]
    v_mfma_f32_16x16x32_bf16 v[56:59], v[144:147], v[136:139], v[56:59]
    s_waitcnt lgkmcnt(6)
    v_mfma_f32_16x16x32_bf16 v[60:63], v[144:147], v[152:155], v[60:63]
    s_waitcnt lgkmcnt(4)
    v_mfma_f32_16x16x32_bf16 v[36:39], v[160:163], v[76:79], v[36:39]
    v_mfma_f32_16x16x32_bf16 v[40:43], v[160:163], v[72:75], v[40:43]
    v_mfma_f32_16x16x32_bf16 v[44:47], v[160:163], v[68:71], v[44:47]
    v_mfma_f32_16x16x32_bf16 v[48:51], v[160:163], v[64:67], v[48:51]
    v_mfma_f32_16x16x32_bf16 v[52:55], v[160:163], v[136:139], v[52:55]
    v_mfma_f32_16x16x32_bf16 v[56:59], v[160:163], v[152:155], v[56:59]
    s_waitcnt lgkmcnt(3)
    v_mfma_f32_16x16x32_bf16 v[60:63], v[160:163], v[168:171], v[60:63]
    s_waitcnt lgkmcnt(1)
    v_mfma_f32_16x16x32_bf16 v[32:35], v[176:179], v[76:79], v[32:35]
    v_mfma_f32_16x16x32_bf16 v[36:39], v[176:179], v[72:75], v[36:39]
    v_mfma_f32_16x16x32_bf16 v[40:43], v[176:179], v[68:71], v[40:43]
    v_mfma_f32_16x16x32_bf16 v[44:47], v[176:179], v[64:67], v[44:47]
    v_mfma_f32_16x16x32_bf16 v[48:51], v[176:179], v[136:139], v[48:51]
    v_mfma_f32_16x16x32_bf16 v[52:55], v[176:179], v[152:155], v[52:55]
    v_mfma_f32_16x16x32_bf16 v[56:59], v[176:179], v[168:171], v[56:59]
    s_waitcnt lgkmcnt(0)
    v_mfma_f32_16x16x32_bf16 v[60:63], v[176:179], v[132:135], v[60:63]
    s_lshl_b32 s60, s52, 12
    s_add_u32 s60, s60, s98
    v_add_u32 v8, s60, v2
    s_xor_b32 s61, s52, 2
    s_lshl_b32 s61, s61, 12
    s_add_u32 s61, s61, s98
    v_add_u32 v9, s61, v2
    s_cmp_eq_u32 s6, 0
    s_nop 1
    s_cbranch_scc1 L_h0_42
    v_swap_b32 v32, v48
    v_swap_b32 v33, v49
    v_swap_b32 v34, v50
    v_swap_b32 v35, v51
    v_swap_b32 v36, v52
    v_swap_b32 v37, v53
    v_swap_b32 v38, v54
    v_swap_b32 v39, v55
    v_swap_b32 v40, v56
    v_swap_b32 v41, v57
    v_swap_b32 v42, v58
    v_swap_b32 v43, v59
    v_swap_b32 v44, v60
    v_swap_b32 v45, v61
    v_swap_b32 v46, v62
    v_swap_b32 v47, v63
L_h0_42:
    ds_write_b128 v8, v[48:51] offset:0
    ds_write_b128 v8, v[52:55] offset:1024
    ds_write_b128 v8, v[56:59] offset:2048
    ds_write_b128 v8, v[60:63] offset:3072
    s_add_u32 s99, s99, 1
    v_mov_b32 v29, s99
    s_waitcnt lgkmcnt(0)
    ds_write_b32 v27, v29
    s_mov_b32 s59, 1000000
L_ps_43:
    ds_read_b32 v29, v28
    s_waitcnt lgkmcnt(0)
    v_cmp_gt_u32 vcc, s99, v29
    s_cbranch_vccz L_psd_44
    s_sleep 1
    s_sub_u32 s59, s59, 1
    s_cbranch_scc0 L_ps_43
L_psd_44:
    ds_read_b128 v[64:67], v9 offset:0
    ds_read_b128 v[68:71], v9 offset:1024
    ds_read_b128 v[72:75], v9 offset:2048
    ds_read_b128 v[76:79], v9 offset:3072
    v_lshlrev_b32 v8, 5, v7
    v_lshl_add_u32 v8, v6, 3, v8
    v_add_u32 v8, s61, v8
    s_lshl_b32 s60, s6, 11
    s_add_u32 s60, s60, s96
    s_add_u32 s60, s60, 3670016
    s_mul_i32 s62, s6, 640
    s_add_u32 s62, s62, s58
    s_lshl_b32 s62, s62, 4
    s_add_u32 s91, s62, 851968
    s_waitcnt lgkmcnt(0)
    v_add_f32 v32, v32, v64
    v_add_f32 v33, v33, v65
    v_add_f32 v34, v34, v66
    v_add_f32 v35, v35, v67
    v_cvt_pk_bf16_f32 v80, v32, v33
    v_cvt_pk_bf16_f32 v81, v34, v35
    ds_write_b64 v8, v[80:81] offset:0
    v_add_f32 v36, v36, v68
    v_add_f32 v37, v37, v69
    v_add_f32 v38, v38, v70
    v_add_f32 v39, v39, v71
    v_cvt_pk_bf16_f32 v82, v36, v37
    v_cvt_pk_bf16_f32 v83, v38, v39
    ds_write_b64 v8, v[82:83] offset:512
    v_add_f32 v40, v40, v72
    v_add_f32 v41, v41, v73
    v_add_f32 v42, v42, v74
    v_add_f32 v43, v43, v75
    v_cvt_pk_bf16_f32 v84, v40, v41
    v_cvt_pk_bf16_f32 v85, v42, v43
    ds_write_b64 v8, v[84:85] offset:1024
    v_add_f32 v44, v44, v76
    v_add_f32 v45, v45, v77
    v_add_f32 v46, v46, v78
    v_add_f32 v47, v47, v79
    v_cvt_pk_bf16_f32 v86, v44, v45
    v_cvt_pk_bf16_f32 v87, v46, v47
    ds_write_b64 v8, v[86:87] offset:1536
    s_waitcnt lgkmcnt(0)
    ds_read_b128 v[96:99], v9 offset:0
    ds_read_b128 v[100:103], v9 offset:1024
    s_waitcnt lgkmcnt(1)
    buffer_store_dwordx4 v[96:99], v2, s[36:39], s60 offen offset:0 sc1
    s_waitcnt lgkmcnt(0)
    buffer_store_dwordx4 v[100:103], v2, s[36:39], s60 offen offset:1024 sc1
    s_setprio 0
    s_cmp_lt_u32 s7, 4
    s_cbranch_scc1 L_pc6
L_lg2:
    s_add_u32 s96, s52, 0
    s_and_b32 s96, s96, 3
    s_lshl_b32 s60, s56, 6
    s_lshl_b32 s61, s96, 4
    s_add_u32 s60, s60, s61
    s_lshl_b32 s61, s60, 4
    s_add_u32 s61, s61, 98304
    v_and_b32 v4, 15, v1
    v_lshl_add_u32 v14, v4, 4, s61
    buffer_load_dwordx4 v[20:23], v14, s[36:39], 0 offen sc1
    s_mul_i32 s60, s60, 1280
    s_mul_i32 s61, s57, 160
    s_add_u32 s5, s60, s61
    s_xor_b32 s3, s52, 2
    s_lshl_b32 s3, s3, 12
    s_add_u32 s3, s3, s98
    s_mov_b32 m0, s3
    v_add_u32 v4, 0, v1
    v_mul_u32_u24 v5, 6554, v4
    v_lshrrev_b32 v5, 16, v5
    v_mul_u32_u24 v6, 10, v5
    v_sub_u32 v6, v4, v6
    v_mul_u32_u24 v5, 1280, v5
    v_lshl_add_u32 v16, v6, 4, v5
    v_add_u32 v4, 64, v1
    v_mul_u32_u24 v5, 6554, v4
    v_lshrrev_b32 v5, 16, v5
    v_mul_u32_u24 v6, 10, v5
    v_sub_u32 v6, v4, v6
    v_mul_u32_u24 v5, 1280, v5
    v_lshl_add_u32 v17, v6, 4, v5
    v_add_u32 v4, 128, v1
    v_mul_u32_u24 v5, 6554, v4
    v_lshrrev_b32 v5, 16, v5
    v_mul_u32_u24 v6, 10, v5
    v_sub_u32 v6, v4, v6
    v_mul_u32_u24 v5, 1280, v5
    v_lshl_add_u32 v18, v6, 4, v5
    v_cmp_lt_u32 vcc, 31, v1
    v_mov_b32 v4, 0x80000000
    s_nop 0
    v_cndmask_b32 v18, v18, v4, vcc
    v_subrev_u32 v4, 1024, v17
    v_subrev_u32 v5, 2048, v18
    buffer_load_dwordx4 v16, s[8:11], s5 offen lds
    buffer_load_dwordx4 v4, s[8:11], s5 offen offset:1024 lds
    buffer_load_dwordx4 v5, s[8:11], s5 offen offset:2048 lds
    s_and_b32 s60, s52, 1
    s_mul_i32 s60, s60, 40
    v_min_u32 v6, 39, v1
    s_mul_i32 s61, s57, 80
    s_add_u32 s61, s61, s60
    s_lshr_b32 s62, s56, 4
    s_mul_i32 s62, s62, 640
    s_add_u32 s62, s62, s61
    v_add_u32 v6, s62, v6
    v_lshlrev_b32 v6, 4, v6
    v_add_u32 v6, 851968, v6
    s_lshl_b32 s4, s61, 12
    s_lshl_b32 s61, s56, 7
    s_add_u32 s4, s4, s61
    s_add_u32 s4, s4, 3670016
    s_lshl_b32 s6, s60, 7
    s_add_u32 s6, s6, s19
    v_lshrrev_b32 v7, 3, v1
    v_lshlrev_b32 v7, 12, v7
    v_and_b32 v4, 7, v1
    v_lshl_add_u32 v7, v4, 4, v7
    v_and_b32 v4, 15, v1
    v_lshrrev_b32 v5, 4, v1
    v_mul_u32_u24 v8, 160, v4
    v_lshl_add_u32 v8, v5, 3, v8
    v_add_u32 v8, s3, v8
    v_lshrrev_b32 v9, 2, v4
    v_lshl_add_u32 v9, v5, 2, v9
    v_lshlrev_b32 v9, 7, v9
    v_and_b32 v4, 3, v1
    v_lshl_add_u32 v9, v4, 3, v9
    s_lshl_b32 s60, s96, 5
    s_add_u32 s60, s60, s19
    v_add_u32 v9, s60, v9
    v_lshlrev_b32 v10, 2, v4
    v_add_u32 v10, 163808, v10
    s_mul_i32 s60, s52, 20480
    v_add_u32 v11, s60, v2
    s_lshl_b32 s60, s56, 3
    s_add_u32 s60, s60, s57
    s_lshl_b32 s60, s60, 2
    s_add_u32 s60, s60, s52
    s_lshl_b32 s93, s60, 12
    s_add_u32 s93, s93, 15728640
    s_xor_b32 s94, s93, 131072
    s_add_u32 s88, s52, 2
    s_add_u32 s89, s52, 6
    s_waitcnt vmcnt(4)
    s_mov_b64 exec, 1
    buffer_store_dwordx2 v[24:25], v26, s[36:39], s91 offen sc1
    s_mov_b64 exec, -1
    s_mov_b32 s59, 20000
    s_waitcnt vmcnt(1)
L_chk_st2_45:
    v_cmp_ne_u64 s[60:61], s[48:49], v[22:23]
    s_cmp_eq_u64 s[60:61], 0
    s_cbranch_scc1 L_chkok_st2_46
    s_sub_u32 s59, s59, 1
    s_cbranch_scc1 L_chkok_st2_46
    s_sleep 6
    buffer_load_dwordx4 v[20:23], v14, s[36:39], 0 offen sc1
    s_waitcnt vmcnt(0)
    s_branch L_chk_st2_45
L_chkok_st2_46:
    ds_read_b64 v[112:113], v8 offset:0
    ds_read_b64 v[114:115], v8 offset:32
    ds_read_b64 v[116:117], v8 offset:64
    ds_read_b64 v[118:119], v8 offset:96
    ds_read_b64 v[120:121], v8 offset:128
    s_mov_b32 s63, 0xffff0000
    v_mul_f32 v22, 0xbfb8aa3b, v21
    v_mul_f32 v23, v21, v21
    s_waitcnt lgkmcnt(0)
    v_lshlrev_b32 v152, 16, v112
    v_and_b32 v153, s63, v112
    v_sub_f32 v132, v152, v20
    v_sub_f32 v133, v153, v20
    v_mul_f32 v132, v132, v23
    v_mul_f32 v133, v133, v23
    v_lshlrev_b32 v154, 16, v113
    v_and_b32 v155, s63, v113
    v_sub_f32 v134, v154, v20
    v_sub_f32 v135, v155, v20
    v_mul_f32 v134, v134, v23
    v_mul_f32 v135, v135, v23
    v_lshlrev_b32 v156, 16, v114
    v_and_b32 v157, s63, v114
    v_sub_f32 v136, v156, v20
    v_sub_f32 v137, v157, v20
    v_mul_f32 v136, v136, v23
    v_mul_f32 v137, v137, v23
    v_lshlrev_b32 v158, 16, v115
    v_and_b32 v159, s63, v115
    v_sub_f32 v138, v158, v20
    v_sub_f32 v139, v159, v20
    v_mul_f32 v138, v138, v23
    v_mul_f32 v139, v139, v23
    v_lshlrev_b32 v160, 16, v116
    v_and_b32 v161, s63, v116
    v_sub_f32 v140, v160, v20
    v_sub_f32 v141, v161, v20
    v_mul_f32 v140, v140, v23
    v_mul_f32 v141, v141, v23
    v_lshlrev_b32 v162, 16, v117
    v_and_b32 v163, s63, v117
    v_sub_f32 v142, v162, v20
    v_sub_f32 v143, v163, v20
    v_mul_f32 v142, v142, v23
    v_mul_f32 v143, v143, v23
    v_lshlrev_b32 v164, 16, v118
    v_and_b32 v165, s63, v118
    v_sub_f32 v144, v164, v20
    v_sub_f32 v145, v165, v20
    v_mul_f32 v144, v144, v23
    v_mul_f32 v145, v145, v23
    v_lshlrev_b32 v166, 16, v119
    v_and_b32 v167, s63, v119
    v_sub_f32 v146, v166, v20
    v_sub_f32 v147, v167, v20
    v_mul_f32 v146, v146, v23
    v_mul_f32 v147, v147, v23
    v_lshlrev_b32 v168, 16, v120
    v_and_b32 v169, s63, v120
    v_sub_f32 v148, v168, v20
    v_sub_f32 v149, v169, v20
    v_mul_f32 v148, v148, v23
    v_mul_f32 v149, v149, v23
    v_lshlrev_b32 v170, 16, v121
    v_and_b32 v171, s63, v121
    v_sub_f32 v150, v170, v20
    v_sub_f32 v151, v171, v20
    v_mul_f32 v150, v150, v23
    v_mul_f32 v151, v151, v23
    s_cmp_lt_u32 s52, 2
    s_cselect_b32 s18, 1, 0
    s_branch L_y2_47
    s_mov_b32 s18, 0
    s_cmp_lt_u32 s52, 2
    s_cbranch_scc1 L_y2_47
    s_mov_b32 s59, 1000000
L_lw_ys_48:
    ds_read_b32 v29, v10
    s_waitcnt lgkmcnt(0)
    v_cmp_gt_u32 vcc, 3, v29
    s_cbranch_vccz L_lwd_ys_49
    s_sleep 1
    s_sub_u32 s59, s59, 1
    s_cbranch_scc0 L_lw_ys_48
L_lwd_ys_49:
    v_mov_b32 v224, s48
    v_mov_b32 v225, s49
    s_mov_b32 exec_lo, 4294967295
    s_mov_b32 exec_hi, 255
    v_mov_b32 v224, 0
    v_mov_b32 v225, 0
    buffer_atomic_or_x2 v[224:225], v6, s[36:39], 0 offen sc0 sc1
    s_mov_b64 exec, -1
    s_waitcnt vmcnt(0)
    v_cmp_ne_u64 vcc, s[48:49], v[224:225]
    s_mov_b32 s18, 1
    s_cbranch_vccnz L_y2_47
    s_mov_b32 s18, 0
    s_mov_b32 m0, s6
    v_add_u32 v4, 0, v7
    buffer_load_dwordx4 v4, s[36:39], s4 offen offset:0 sc1 lds
    v_add_u32 v4, 31744, v7
    buffer_load_dwordx4 v4, s[36:39], s4 offen offset:1024 sc1 lds
    v_add_u32 v4, 63488, v7
    buffer_load_dwordx4 v4, s[36:39], s4 offen offset:2048 sc1 lds
    v_add_u32 v4, 95232, v7
    buffer_load_dwordx4 v4, s[36:39], s4 offen offset:3072 sc1 lds
    s_add_u32 m0, s6, 4096
    v_add_u32 v4, 131072, v7
    buffer_load_dwordx4 v4, s[36:39], s4 offen offset:0 sc1 lds
    s_waitcnt vmcnt(0)
    v_mov_b32 v13, 163768
    v_mov_b32 v30, 1
    v_lshl_add_u32 v13, s52, 2, v13
    ds_write_b32 v13, v30
L_y2_47:
    s_mov_b32 s59, 1000000
L_lw_r1_50:
    ds_read_b32 v29, v10
    s_waitcnt lgkmcnt(0)
    v_cmp_gt_u32 vcc, s88, v29
    s_cbranch_vccz L_lwd_r1_51
    s_sleep 1
    s_sub_u32 s59, s59, 1
    s_cbranch_scc0 L_lw_r1_50
L_lwd_r1_51:
    s_cmp_lg_u32 s18, 0
    s_cselect_b32 s60, 0, 0x80000000
    v_mov_b32 v224, s48
    v_mov_b32 v225, s49
    s_mov_b32 exec_lo, 4294967295
    s_mov_b32 exec_hi, 255
    v_mov_b32 v224, 0
    v_mov_b32 v225, 0
    buffer_atomic_or_x2 v[224:225], v6, s[36:39], s60 offen sc0 sc1
    s_mov_b64 exec, -1
    ds_read_b128 v[32:35], v11 offset:0
    ds_read_b128 v[36:39], v11 offset:1024
    ds_read_b128 v[40:43], v11 offset:2048
    ds_read_b128 v[44:47], v11 offset:3072
    ds_read_b128 v[48:51], v11 offset:4096
    ds_read_b128 v[52:55], v11 offset:5120
    ds_read_b128 v[56:59], v11 offset:6144
    ds_read_b128 v[60:63], v11 offset:7168
    ds_read_b128 v[64:67], v11 offset:8192
    ds_read_b128 v[68:71], v11 offset:9216
    ds_read_b128 v[72:75], v11 offset:10240
    ds_read_b128 v[76:79], v11 offset:11264
    ds_read_b128 v[80:83], v11 offset:12288
    ds_read_b128 v[84:87], v11 offset:13312
    ds_read_b128 v[88:91], v11 offset:14336
    ds_read_b128 v[92:95], v11 offset:15360
    ds_read_b128 v[96:99], v11 offset:16384
    ds_read_b128 v[100:103], v11 offset:17408
    ds_read_b128 v[104:107], v11 offset:18432
    ds_read_b128 v[108:111], v11 offset:19456
    v_mov_b32 v30, 2
    ds_write_b32 v27, v30 offset:32
    s_waitcnt lgkmcnt(11)
    v_add_f32 v32, v32, v52
    v_add_f32 v33, v33, v53
    v_add_f32 v34, v34, v54
    v_add_f32 v35, v35, v55
    v_add_f32 v36, v36, v56
    v_add_f32 v37, v37, v57
    v_add_f32 v38, v38, v58
    v_add_f32 v39, v39, v59
    v_add_f32 v40, v40, v60
    v_add_f32 v41, v41, v61
    v_add_f32 v42, v42, v62
    v_add_f32 v43, v43, v63
    v_add_f32 v44, v44, v64
    v_add_f32 v45, v45, v65
    v_add_f32 v46, v46, v66
    v_add_f32 v47, v47, v67
    v_add_f32 v48, v48, v68
    v_add_f32 v49, v49, v69
    v_add_f32 v50, v50, v70
    v_add_f32 v51, v51, v71
    s_waitcnt lgkmcnt(1)
    v_mov_b32 v195, s48
    v_mov_b32 v199, s48
    v_mov_b32 v203, s48
    v_mov_b32 v207, s48
    v_add_f32 v72, v72, v92
    v_add_f32 v73, v73, v93
    v_add_f32 v74, v74, v94
    v_add_f32 v75, v75, v95
    v_add_f32 v32, v32, v72
    v_add_f32 v33, v33, v73
    v_add_f32 v34, v34, v74
    v_add_f32 v35, v35, v75
    v_cvt_pk_bf16_f32 v192, v32, v33
    v_cvt_pk_bf16_f32 v193, v34, v35
    v_add_f32 v76, v76, v96
    v_add_f32 v77, v77, v97
    v_add_f32 v78, v78, v98
    v_add_f32 v79, v79, v99
    v_add_f32 v36, v36, v76
    v_add_f32 v37, v37, v77
    v_add_f32 v38, v38, v78
    v_add_f32 v39, v39, v79
    v_cvt_pk_bf16_f32 v194, v36, v37
    buffer_store_dwordx4 v[192:195], v2, s[36:39], s94 offen offset:0 sc1
    v_cvt_pk_bf16_f32 v196, v38, v39
    v_add_f32 v80, v80, v100
    v_add_f32 v81, v81, v101
    v_add_f32 v82, v82, v102
    v_add_f32 v83, v83, v103
    v_add_f32 v40, v40, v80
    v_add_f32 v41, v41, v81
    v_add_f32 v42, v42, v82
    v_add_f32 v43, v43, v83
    v_cvt_pk_bf16_f32 v197, v40, v41
    v_cvt_pk_bf16_f32 v198, v42, v43
    buffer_store_dwordx4 v[196:199], v2, s[36:39], s94 offen offset:1024 sc1
    v_add_f32 v84, v84, v104
    v_add_f32 v85, v85, v105
    v_add_f32 v86, v86, v106
    v_add_f32 v87, v87, v107
    v_add_f32 v44, v44, v84
    v_add_f32 v45, v45, v85
    v_add_f32 v46, v46, v86
    v_add_f32 v47, v47, v87
    v_cvt_pk_bf16_f32 v200, v44, v45
    v_cvt_pk_bf16_f32 v201, v46, v47
    v_add_f32 v88, v88, v108
    v_add_f32 v89, v89, v109
    v_add_f32 v90, v90, v110
    v_add_f32 v91, v91, v111
    v_add_f32 v48, v48, v88
    v_add_f32 v49, v49, v89
    v_add_f32 v50, v50, v90
    v_add_f32 v51, v51, v91
    v_cvt_pk_bf16_f32 v202, v48, v49
    buffer_store_dwordx4 v[200:203], v2, s[36:39], s94 offen offset:2048 sc1
    v_cvt_pk_bf16_f32 v204, v50, v51
    buffer_store_dwordx4 v[204:207], v2, s[36:39], s94 offen offset:3072 sc1
    s_cmp_eq_u32 s18, 0
    s_cbranch_scc1 L_y4_52
    s_waitcnt vmcnt(4)
    v_cmp_ne_u64 vcc, s[48:49], v[224:225]
    s_cbranch_vccz L_polld_y_54
    s_mov_b32 s59, 20000
L_poll_y_53:
    s_sleep 6
    v_mov_b32 v224, s48
    v_mov_b32 v225, s49
    s_mov_b32 exec_lo, 4294967295
    s_mov_b32 exec_hi, 255
    v_mov_b32 v224, 0
    v_mov_b32 v225, 0
    buffer_atomic_or_x2 v[224:225], v6, s[36:39], 0 offen sc0 sc1
    s_mov_b64 exec, -1
    s_waitcnt vmcnt(0)
    v_cmp_ne_u64 vcc, s[48:49], v[224:225]
    s_cbranch_vccz L_polld_y_54
    s_sub_u32 s59, s59, 1
    s_cbranch_scc0 L_poll_y_53
L_polld_y_54:
    s_mov_b32 m0, s6
    v_add_u32 v4, 0, v7
    buffer_load_dwordx4 v4, s[36:39], s4 offen offset:0 sc1 lds
    v_add_u32 v4, 31744, v7
    buffer_load_dwordx4 v4, s[36:39], s4 offen offset:1024 sc1 lds
    v_add_u32 v4, 63488, v7
    buffer_load_dwordx4 v4, s[36:39], s4 offen offset:2048 sc1 lds
    v_add_u32 v4, 95232, v7
    buffer_load_dwordx4 v4, s[36:39], s4 offen offset:3072 sc1 lds
    s_add_u32 m0, s6, 4096
    v_add_u32 v4, 131072, v7
    buffer_load_dwordx4 v4, s[36:39], s4 offen offset:0 sc1 lds
    s_waitcnt vmcnt(0)
    v_mov_b32 v13, 163768
    v_mov_b32 v30, 1
    v_lshl_add_u32 v13, s52, 2, v13
    ds_write_b32 v13, v30
L_y4_52:
    s_sub_u32 s88, s89, 2
    s_mov_b32 s59, 1000000
L_lw_r15_55:
    ds_read_b32 v29, v10
    s_waitcnt lgkmcnt(0)
    v_cmp_gt_u32 vcc, s88, v29
    s_cbranch_vccz L_lwd_r15_56
    s_sleep 1
    s_sub_u32 s59, s59, 1
    s_cbranch_scc0 L_lw_r15_55
L_lwd_r15_56:
    buffer_load_dwordx4 v[208:211], v2, s[36:39], s93 offen offset:0 sc1
    buffer_load_dwordx4 v[212:215], v2, s[36:39], s93 offen offset:1024 sc1
    buffer_load_dwordx4 v[216:219], v2, s[36:39], s93 offen offset:2048 sc1
    buffer_load_dwordx4 v[220:223], v2, s[36:39], s93 offen offset:3072 sc1
    v_and_b32 v13, 1, v1
    v_lshlrev_b32 v13, 2, v13
    v_add_u32 v13, 163768, v13
    s_mov_b32 s59, 1000000
L_lw_yok_57:
    ds_read_b32 v29, v13
    s_waitcnt lgkmcnt(0)
    v_cmp_gt_u32 vcc, 1, v29
    s_cbranch_vccz L_lwd_yok_58
    s_sleep 1
    s_sub_u32 s59, s59, 1
    s_cbranch_scc0 L_lw_yok_57
L_lwd_yok_58:
    ds_read_b64_tr_b16 v[122:123], v9 offset:0
    ds_read_b64_tr_b16 v[124:125], v9 offset:2048
    ds_read_b64_tr_b16 v[126:127], v9 offset:4096
    ds_read_b64_tr_b16 v[128:129], v9 offset:6144
    ds_read_b64_tr_b16 v[130:131], v9 offset:8192
    s_waitcnt lgkmcnt(0)
    v_lshlrev_b32 v4, 16, v122
    v_and_b32 v5, s63, v122
    v_mul_f32 v132, v132, v4
    v_mul_f32 v133, v133, v5
    v_lshlrev_b32 v4, 16, v123
    v_and_b32 v5, s63, v123
    v_mul_f32 v134, v134, v4
    v_mul_f32 v135, v135, v5
    v_lshlrev_b32 v4, 16, v124
    v_and_b32 v5, s63, v124
    v_mul_f32 v136, v136, v4
    v_mul_f32 v137, v137, v5
    v_lshlrev_b32 v4, 16, v125
    v_and_b32 v5, s63, v125
    v_mul_f32 v138, v138, v4
    v_mul_f32 v139, v139, v5
    v_lshlrev_b32 v4, 16, v126
    v_and_b32 v5, s63, v126
    v_mul_f32 v140, v140, v4
    v_mul_f32 v141, v141, v5
    v_lshlrev_b32 v4, 16, v127
    v_and_b32 v5, s63, v127
    v_mul_f32 v142, v142, v4
    v_mul_f32 v143, v143, v5
    v_lshlrev_b32 v4, 16, v128
    v_and_b32 v5, s63, v128
    v_mul_f32 v144, v144, v4
    v_mul_f32 v145, v145, v5
    v_lshlrev_b32 v4, 16, v129
    v_and_b32 v5, s63, v129
    v_mul_f32 v146, v146, v4
    v_mul_f32 v147, v147, v5
    v_lshlrev_b32 v4, 16, v130
    v_and_b32 v5, s63, v130
    v_mul_f32 v148, v148, v4
    v_mul_f32 v149, v149, v5
    v_lshlrev_b32 v4, 16, v131
    v_and_b32 v5, s63, v131
    v_mul_f32 v150, v150, v4
    v_mul_f32 v151, v151, v5
    s_mov_b32 s59, 20000
L_z_59:
    s_waitcnt vmcnt(0)
    v_cmp_ne_u32 s[60:61], s48, v211
    v_cmp_ne_u32 vcc, s48, v215
    s_or_b64 s[60:61], s[60:61], vcc
    v_cmp_ne_u32 vcc, s48, v219
    s_or_b64 s[60:61], s[60:61], vcc
    v_cmp_ne_u32 vcc, s48, v223
    s_or_b64 s[60:61], s[60:61], vcc
    s_cbranch_scc0 L_zd_60
    s_sub_u32 s59, s59, 1
    s_cbranch_scc1 L_zd_60
    s_sleep 4
    buffer_load_dwordx4 v[208:211], v2, s[36:39], s93 offen offset:0 sc1
    buffer_load_dwordx4 v[212:215], v2, s[36:39], s93 offen offset:1024 sc1
    buffer_load_dwordx4 v[216:219], v2, s[36:39], s93 offen offset:2048 sc1
    buffer_load_dwordx4 v[220:223], v2, s[36:39], s93 offen offset:3072 sc1
    s_branch L_z_59
L_zd_60:
    v_lshlrev_b32 v172, 16, v208
    v_and_b32 v173, s63, v208
    v_lshlrev_b32 v174, 16, v209
    v_and_b32 v175, s63, v209
    v_lshlrev_b32 v176, 16, v210
    v_and_b32 v177, s63, v210
    v_lshlrev_b32 v178, 16, v212
    v_and_b32 v179, s63, v212
    v_lshlrev_b32 v180, 16, v213
    v_and_b32 v181, s63, v213
    v_lshlrev_b32 v182, 16, v214
    v_and_b32 v183, s63, v214
    v_lshlrev_b32 v184, 16, v216
    v_and_b32 v185, s63, v216
    v_lshlrev_b32 v186, 16, v217
    v_and_b32 v187, s63, v217
    v_lshlrev_b32 v188, 16, v218
    v_and_b32 v189, s63, v218
    v_lshlrev_b32 v190, 16, v220
    v_and_b32 v191, s63, v220
    s_mov_b32 s59, 1000000
L_lw_r2_61:
    ds_read_b32 v29, v10
    s_waitcnt lgkmcnt(0)
    v_cmp_gt_u32 vcc, s89, v29
    s_cbranch_vccz L_lwd_r2_62
    s_sleep 1
    s_sub_u32 s59, s59, 1
    s_cbranch_scc0 L_lw_r2_61
L_lwd_r2_62:
    ds_read_b128 v[32:35], v11 offset:0
    ds_read_b128 v[52:55], v11 offset:5120
    ds_read_b128 v[72:75], v11 offset:10240
    ds_read_b128 v[92:95], v11 offset:15360
    ds_read_b128 v[36:39], v11 offset:1024
    ds_read_b128 v[56:59], v11 offset:6144
    ds_read_b128 v[76:79], v11 offset:11264
    ds_read_b128 v[96:99], v11 offset:16384
    ds_read_b128 v[40:43], v11 offset:2048
    ds_read_b128 v[60:63], v11 offset:7168
    ds_read_b128 v[80:83], v11 offset:12288
    ds_read_b128 v[100:103], v11 offset:17408
    ds_read_b128 v[44:47], v11 offset:3072
    ds_read_b128 v[64:67], v11 offset:8192
    ds_read_b128 v[84:87], v11 offset:13312
    ds_read_b128 v[104:107], v11 offset:18432
    ds_read_b128 v[48:51], v11 offset:4096
    ds_read_b128 v[68:71], v11 offset:9216
    ds_read_b128 v[88:91], v11 offset:14336
    ds_read_b128 v[108:111], v11 offset:19456
    s_waitcnt vmcnt(0)
    s_waitcnt lgkmcnt(15)
    v_pk_add_f32 v[32:33], v[32:33], v[52:53]
    v_pk_add_f32 v[72:73], v[72:73], v[92:93]
    v_pk_add_f32 v[34:35], v[34:35], v[54:55]
    v_pk_add_f32 v[74:75], v[74:75], v[94:95]
    v_pk_add_f32 v[172:173], v[172:173], v[32:33]
    v_pk_add_f32 v[174:175], v[174:175], v[34:35]
    v_pk_add_f32 v[172:173], v[172:173], v[72:73]
    v_pk_add_f32 v[174:175], v[174:175], v[74:75]
    v_pk_mul_f32 v[32:33], v[172:173], v[22:23] op_sel_hi:[1,0]
    v_pk_mul_f32 v[34:35], v[174:175], v[22:23] op_sel_hi:[1,0]
    v_exp_f32 v32, v32
    v_exp_f32 v33, v33
    v_exp_f32 v34, v34
    v_exp_f32 v35, v35
    v_pk_mul_f32 v[172:173], v[172:173], v[132:133]
    v_pk_mul_f32 v[174:175], v[174:175], v[134:135]
    v_pk_add_f32 v[32:33], v[32:33], 1.0 op_sel_hi:[1,0]
    v_pk_add_f32 v[34:35], v[34:35], 1.0 op_sel_hi:[1,0]
    v_rcp_f32 v32, v32
    v_rcp_f32 v33, v33
    v_rcp_f32 v34, v34
    v_rcp_f32 v35, v35
    s_nop 0
    v_pk_fma_f32 v[32:33], v[172:173], v[32:33], v[152:153]
    v_pk_fma_f32 v[34:35], v[174:175], v[34:35], v[154:155]
    v_cvt_pk_bf16_f32 v112, v32, v33
    v_cvt_pk_bf16_f32 v113, v34, v35
    ds_write_b64 v8, v[112:113] offset:0
    s_waitcnt lgkmcnt(13)
    v_pk_add_f32 v[36:37], v[36:37], v[56:57]
    v_pk_add_f32 v[76:77], v[76:77], v[96:97]
    v_pk_add_f32 v[38:39], v[38:39], v[58:59]
    v_pk_add_f32 v[78:79], v[78:79], v[98:99]
    v_pk_add_f32 v[176:177], v[176:177], v[36:37]
    v_pk_add_f32 v[178:179], v[178:179], v[38:39]
    v_pk_add_f32 v[176:177], v[176:177], v[76:77]
    v_pk_add_f32 v[178:179], v[178:179], v[78:79]
    v_pk_mul_f32 v[36:37], v[176:177], v[22:23] op_sel_hi:[1,0]
    v_pk_mul_f32 v[38:39], v[178:179], v[22:23] op_sel_hi:[1,0]
    v_exp_f32 v36, v36
    v_exp_f32 v37, v37
    v_exp_f32 v38, v38
    v_exp_f32 v39, v39
    v_pk_mul_f32 v[176:177], v[176:177], v[136:137]
    v_pk_mul_f32 v[178:179], v[178:179], v[138:139]
    v_pk_add_f32 v[36:37], v[36:37], 1.0 op_sel_hi:[1,0]
    v_pk_add_f32 v[38:39], v[38:39], 1.0 op_sel_hi:[1,0]
    v_rcp_f32 v36, v36
    v_rcp_f32 v37, v37
    v_rcp_f32 v38, v38
    v_rcp_f32 v39, v39
    s_nop 0
    v_pk_fma_f32 v[36:37], v[176:177], v[36:37], v[156:157]
    v_pk_fma_f32 v[38:39], v[178:179], v[38:39], v[158:159]
    v_cvt_pk_bf16_f32 v114, v36, v37
    v_cvt_pk_bf16_f32 v115, v38, v39
    ds_write_b64 v8, v[114:115] offset:32
    s_waitcnt lgkmcnt(10)
    v_pk_add_f32 v[40:41], v[40:41], v[60:61]
    v_pk_add_f32 v[80:81], v[80:81], v[100:101]
    v_pk_add_f32 v[42:43], v[42:43], v[62:63]
    v_pk_add_f32 v[82:83], v[82:83], v[102:103]
    v_pk_add_f32 v[180:181], v[180:181], v[40:41]
    v_pk_add_f32 v[182:183], v[182:183], v[42:43]
    v_pk_add_f32 v[180:181], v[180:181], v[80:81]
    v_pk_add_f32 v[182:183], v[182:183], v[82:83]
    v_pk_mul_f32 v[40:41], v[180:181], v[22:23] op_sel_hi:[1,0]
    v_pk_mul_f32 v[42:43], v[182:183], v[22:23] op_sel_hi:[1,0]
    v_exp_f32 v40, v40
    v_exp_f32 v41, v41
    v_exp_f32 v42, v42
    v_exp_f32 v43, v43
    v_pk_mul_f32 v[180:181], v[180:181], v[140:141]
    v_pk_mul_f32 v[182:183], v[182:183], v[142:143]
    v_pk_add_f32 v[40:41], v[40:41], 1.0 op_sel_hi:[1,0]
    v_pk_add_f32 v[42:43], v[42:43], 1.0 op_sel_hi:[1,0]
    v_rcp_f32 v40, v40
    v_rcp_f32 v41, v41
    v_rcp_f32 v42, v42
    v_rcp_f32 v43, v43
    s_nop 0
    v_pk_fma_f32 v[40:41], v[180:181], v[40:41], v[160:161]
    v_pk_fma_f32 v[42:43], v[182:183], v[42:43], v[162:163]
    v_cvt_pk_bf16_f32 v116, v40, v41
    v_cvt_pk_bf16_f32 v117, v42, v43
    ds_write_b64 v8, v[116:117] offset:64
    s_waitcnt lgkmcnt(7)
    v_pk_add_f32 v[44:45], v[44:45], v[64:65]
    v_pk_add_f32 v[84:85], v[84:85], v[104:105]
    v_pk_add_f32 v[46:47], v[46:47], v[66:67]
    v_pk_add_f32 v[86:87], v[86:87], v[106:107]
    v_pk_add_f32 v[184:185], v[184:185], v[44:45]
    v_pk_add_f32 v[186:187], v[186:187], v[46:47]
    v_pk_add_f32 v[184:185], v[184:185], v[84:85]
    v_pk_add_f32 v[186:187], v[186:187], v[86:87]
    v_pk_mul_f32 v[44:45], v[184:185], v[22:23] op_sel_hi:[1,0]
    v_pk_mul_f32 v[46:47], v[186:187], v[22:23] op_sel_hi:[1,0]
    v_exp_f32 v44, v44
    v_exp_f32 v45, v45
    v_exp_f32 v46, v46
    v_exp_f32 v47, v47
    v_pk_mul_f32 v[184:185], v[184:185], v[144:145]
    v_pk_mul_f32 v[186:187], v[186:187], v[146:147]
    v_pk_add_f32 v[44:45], v[44:45], 1.0 op_sel_hi:[1,0]
    v_pk_add_f32 v[46:47], v[46:47], 1.0 op_sel_hi:[1,0]
    v_rcp_f32 v44, v44
    v_rcp_f32 v45, v45
    v_rcp_f32 v46, v46
    v_rcp_f32 v47, v47
    s_nop 0
    v_pk_fma_f32 v[44:45], v[184:185], v[44:45], v[164:165]
    v_pk_fma_f32 v[46:47], v[186:187], v[46:47], v[166:167]
    v_cvt_pk_bf16_f32 v118, v44, v45
    v_cvt_pk_bf16_f32 v119, v46, v47
    ds_write_b64 v8, v[118:119] offset:96
    s_waitcnt lgkmcnt(4)
    v_pk_add_f32 v[48:49], v[48:49], v[68:69]
    v_pk_add_f32 v[88:89], v[88:89], v[108:109]
    v_pk_add_f32 v[50:51], v[50:51], v[70:71]
    v_pk_add_f32 v[90:91], v[90:91], v[110:111]
    v_pk_add_f32 v[188:189], v[188:189], v[48:49]
    v_pk_add_f32 v[190:191], v[190:191], v[50:51]
    v_pk_add_f32 v[188:189], v[188:189], v[88:89]
    v_pk_add_f32 v[190:191], v[190:191], v[90:91]
    v_pk_mul_f32 v[48:49], v[188:189], v[22:23] op_sel_hi:[1,0]
    v_pk_mul_f32 v[50:51], v[190:191], v[22:23] op_sel_hi:[1,0]
    v_exp_f32 v48, v48
    v_exp_f32 v49, v49
    v_exp_f32 v50, v50
    v_exp_f32 v51, v51
    v_pk_mul_f32 v[188:189], v[188:189], v[148:149]
    v_pk_mul_f32 v[190:191], v[190:191], v[150:151]
    v_pk_add_f32 v[48:49], v[48:49], 1.0 op_sel_hi:[1,0]
    v_pk_add_f32 v[50:51], v[50:51], 1.0 op_sel_hi:[1,0]
    v_rcp_f32 v48, v48
    v_rcp_f32 v49, v49
    v_rcp_f32 v50, v50
    v_rcp_f32 v51, v51
    s_nop 0
    v_pk_fma_f32 v[48:49], v[188:189], v[48:49], v[168:169]
    v_pk_fma_f32 v[50:51], v[190:191], v[50:51], v[170:171]
    v_cvt_pk_bf16_f32 v120, v48, v49
    v_cvt_pk_bf16_f32 v121, v50, v51
    ds_write_b64 v8, v[120:121] offset:128
    v_add_u32 v4, s3, v2
    s_waitcnt lgkmcnt(0)
    ds_read_b128 v[200:203], v4 offset:0
    ds_read_b128 v[204:207], v4 offset:1024
    ds_read_b128 v[208:211], v4 offset:2048
    s_waitcnt lgkmcnt(2)
    buffer_store_dwordx4 v[200:203], v16, s[32:35], s5 offen
    s_waitcnt lgkmcnt(1)
    buffer_store_dwordx4 v[204:207], v17, s[32:35], s5 offen
    s_waitcnt lgkmcnt(0)
    buffer_store_dwordx4 v[208:211], v18, s[32:35], s5 offen
    s_branch L_fin
L_p:
    s_mov_b64 s[16:17], s[68:69]
    s_mov_b32 s18, 2621440
    s_mov_b32 s19, 0x20000
    s_mov_b64 s[12:13], s[66:67]
    s_mov_b32 s14, 2621440
    s_mov_b32 s15, 0x20000
    s_mov_b64 s[40:41], s[70:71]
    s_mov_b32 s42, 5120
    s_mov_b32 s43, 0x20000
    s_sub_u32 s93, s2, 224
    s_lshr_b32 s60, s7, 2
    s_add_u32 s94, s60, 7
    s_mul_i32 s92, s60, 21504
    s_add_u32 s92, s92, 4128
    s_mul_i32 s62, s93, 81920
    s_lshl_b32 s63, s94, 7
    s_add_u32 s62, s62, s63
    v_lshrrev_b32 v40, 3, v1
    v_mul_u32_u24 v40, 1280, v40
    v_and_b32 v41, 7, v1
    s_lshl_b32 s63, s52, 1
    v_xor_b32 v42, s63, v41
    v_lshl_add_u32 v42, v42, 4, v40
    s_mul_i32 s63, s52, 20480
    s_add_u32 s63, s63, s62
    s_lshl_b32 s59, s52, 11
    s_add_u32 s59, s59, s92
    s_add_u32 m0, s59, 9216
    v_xor_b32 v43, 16, v42
    buffer_load_dwordx4 v42, s[16:19], s63 offen nt lds
    s_add_u32 m0, s59, 1024
    s_nop 0
    buffer_load_dwordx4 v43, s[12:15], s63 offen nt lds
    s_add_u32 m0, s59, 9216
    v_add_u32 v43, 9216, v43
    buffer_load_dwordx4 v43, s[16:19], s63 offen offset:1024 nt lds
    s_lshl_b32 s60, s52, 1
    s_add_u32 s60, s60, 2
    s_and_b32 s60, s60, 7
    v_xor_b32 v42, s60, v41
    v_lshl_add_u32 v42, v42, 4, v40
    v_add_u32 v42, 9216, v42
    s_add_u32 m0, s59, 1024
    s_lshl_b32 s61, s94, 9
    buffer_load_dwordx4 v42, s[12:15], s63 offen offset:1024 nt lds
    s_cmp_lg_u32 s52, 0
    s_cbranch_scc1 L_nohalo_63
    v_lshl_add_u32 v42, v41, 4, v40
    v_add_u32 v42, s62, v42
    v_subrev_u32 v42, 10240, v42
    v_cmp_gt_u32 vcc, 40, v1
    s_mov_b32 m0, s92
    v_mov_b32 v43, 0x80000000
    v_cndmask_b32 v42, v42, v43, vcc
    buffer_load_dwordx4 v42, s[12:15], 0 offen lds
L_nohalo_63:
    v_lshrrev_b32 v43, 3, v0
    v_lshlrev_b32 v43, 4, v43
    buffer_load_dwordx4 v[44:47], v43, s[40:43], s61 offen
    s_mov_b64 s[36:37], s[86:87]
    s_mov_b32 s38, 268435456
    s_mov_b32 s39, 0x20000
    s_mov_b64 s[20:21], s[72:73]
    s_mov_b32 s22, 2621440
    s_mov_b32 s23, 0x20000
    s_mov_b64 s[44:45], s[74:75]
    s_mov_b32 s46, 1280
    s_mov_b32 s47, 0x20000
    s_mov_b64 s[8:9], s[64:65]
    s_mov_b32 s10, 2621440
    s_mov_b32 s11, 0x20000
    s_mov_b64 s[32:33], s[82:83]
    s_mov_b32 s34, 2621440
    s_mov_b32 s35, 0x20000
    s_mov_b64 s[28:29], s[80:81]
    s_mov_b32 s30, 2211840
    s_mov_b32 s31, 0x20000
    v_and_b32 v100, 7, v0
    v_lshrrev_b32 v101, 5, v0
    v_bfe_u32 v102, v0, 3, 2
    v_xor_b32 v103, v101, v100
    v_lshlrev_b32 v103, 4, v103
    v_lshl_add_u32 v103, v102, 2, v103
    v_lshl_add_u32 v97, v100, 10, v103
    v_add_u32 v98, 9216, v97
    v_add_u32 v97, 0, v97
    v_add_u32 v104, 1, v100
    v_and_b32 v105, 7, v104
    v_xor_b32 v105, v101, v105
    v_lshlrev_b32 v105, 4, v105
    v_lshl_add_u32 v105, v102, 2, v105
    v_lshl_add_u32 v96, v104, 10, v105
    v_add_u32 v96, 0, v96
    v_add_u32 v96, s92, v96
    v_add_u32 v97, s92, v97
    v_add_u32 v98, s92, v98
    s_waitcnt lgkmcnt(0)
    s_add_u32 s48, s48, 0x7F4A7C15
    s_addc_u32 s49, s49, 0x9E3779B9
    v_mov_b32 v24, s48
    v_mov_b32 v25, s49
    s_barrier
    s_cmp_ge_u32 s7, 4
    s_cbranch_scc1 L_pl
    s_mov_b32 s5, 9
    s_waitcnt vmcnt(2)
    s_mul_i32 s62, s93, 81920
    s_lshl_b32 s63, s5, 7
    s_add_u32 s62, s62, s63
    v_lshrrev_b32 v52, 3, v1
    v_mul_u32_u24 v52, 1280, v52
    v_and_b32 v53, 7, v1
    s_lshl_b32 s63, s52, 1
    v_xor_b32 v54, s63, v53
    v_lshl_add_u32 v54, v54, 4, v52
    s_mul_i32 s63, s52, 20480
    s_add_u32 s63, s63, s62
    s_lshl_b32 s59, s52, 11
    s_add_u32 m0, s59, 56352
    v_xor_b32 v55, 16, v54
    buffer_load_dwordx4 v54, s[16:19], s63 offen nt lds
    s_add_u32 m0, s59, 48160
    s_nop 0
    buffer_load_dwordx4 v55, s[12:15], s63 offen nt lds
    s_add_u32 m0, s59, 56352
    v_add_u32 v55, 9216, v55
    buffer_load_dwordx4 v55, s[16:19], s63 offen offset:1024 nt lds
    s_lshl_b32 s60, s52, 1
    s_add_u32 s60, s60, 2
    s_and_b32 s60, s60, 7
    v_xor_b32 v54, s60, v53
    v_lshl_add_u32 v54, v54, 4, v52
    v_add_u32 v54, 9216, v54
    s_add_u32 m0, s59, 48160
    s_lshl_b32 s61, s5, 9
    buffer_load_dwordx4 v54, s[12:15], s63 offen offset:1024 nt lds
    s_cmp_lg_u32 s52, 0
    s_cbranch_scc1 L_nohalo_64
    v_lshl_add_u32 v54, v53, 4, v52
    v_add_u32 v54, s62, v54
    v_subrev_u32 v54, 10240, v54
    v_cmp_gt_u32 vcc, 40, v1
    s_mov_b32 m0, 47136
    v_mov_b32 v55, 0x80000000
    v_cndmask_b32 v54, v54, v55, vcc
    buffer_load_dwordx4 v54, s[12:15], 0 offen lds
L_nohalo_64:
    v_lshrrev_b32 v55, 3, v0
    v_lshlrev_b32 v55, 4, v55
    buffer_load_dwordx4 v[56:59], v55, s[40:43], s61 offen
    s_waitcnt vmcnt(5)
    s_add_u32 s99, s99, 1
    v_mov_b32 v29, s99
    ds_write_b32 v27, v29
    v_and_b32 v30, 3, v1
    v_lshlrev_b32 v30, 2, v30
    v_and_b32 v31, -16, v27
    v_add_u32 v30, v30, v31
    s_mov_b32 s59, 1000000
L_qs_65:
    ds_read_b32 v29, v30
    s_waitcnt lgkmcnt(0)
    v_cmp_gt_u32 vcc, s99, v29
    s_cbranch_vccz L_qsd_66
    s_sleep 1
    s_sub_u32 s59, s59, 1
    s_cbranch_scc0 L_qs_65
L_qsd_66:
    ds_read2_b32 v[100:101], v97 offset0:128 offset1:160
    ds_read2_b32 v[102:103], v97 offset0:192 offset1:224
    ds_read2_b32 v[104:105], v96 offset0:0 offset1:32
    ds_read2_b32 v[106:107], v96 offset0:64 offset1:96
    ds_read2_b32 v[108:109], v96 offset0:128 offset1:160
    ds_read2_b32 v[110:111], v96 offset0:192 offset1:224
    ds_read2_b32 v[116:117], v98 offset0:0 offset1:32
    ds_read2_b32 v[118:119], v98 offset0:64 offset1:96
    ds_read2_b32 v[120:121], v98 offset0:128 offset1:160
    ds_read2_b32 v[122:123], v98 offset0:192 offset1:224
    v_mov_b32 v23, 0xffff0000
    v_lshlrev_b32 v124, 16, v44
    v_lshlrev_b32 v125, 16, v46
    v_and_b32 v126, v23, v44
    v_and_b32 v127, v23, v46
    v_lshlrev_b32 v128, 16, v45
    v_lshlrev_b32 v129, 16, v47
    v_and_b32 v130, v23, v45
    v_and_b32 v131, v23, v47
    v_and_b32 v97, 7, v0
    v_sub_u32 v97, 7, v97
    v_lshlrev_b32 v97, 4, v97
    v_lshrrev_b32 v96, 3, v0
    v_lshl_add_u32 v97, v96, 13, v97
    v_add_u32 v96, 4096, v97
    s_waitcnt lgkmcnt(4)
    v_lshlrev_b32 v132, 16, v101
    v_and_b32 v133, v23, v101
    v_lshlrev_b32 v134, 16, v102
    v_and_b32 v135, v23, v102
    v_lshlrev_b32 v136, 16, v103
    v_and_b32 v137, v23, v103
    v_lshlrev_b32 v138, 16, v104
    v_and_b32 v139, v23, v104
    v_lshlrev_b32 v140, 16, v105
    v_and_b32 v141, v23, v105
    v_lshlrev_b32 v142, 16, v106
    v_and_b32 v143, v23, v106
    v_lshlrev_b32 v144, 16, v107
    v_and_b32 v145, v23, v107
    v_lshlrev_b32 v146, 16, v108
    v_and_b32 v147, v23, v108
    v_lshlrev_b32 v148, 16, v109
    v_and_b32 v149, v23, v109
    v_lshlrev_b32 v150, 16, v110
    v_and_b32 v151, v23, v110
    v_lshlrev_b32 v152, 16, v111
    v_and_b32 v153, v23, v111
    v_pk_mul_f32 v[100:101], v[130:131], v[132:133]
    v_pk_mul_f32 v[102:103], v[130:131], v[134:135]
    v_pk_mul_f32 v[104:105], v[130:131], v[136:137]
    v_pk_mul_f32 v[106:107], v[130:131], v[138:139]
    v_pk_mul_f32 v[108:109], v[130:131], v[140:141]
    v_pk_mul_f32 v[110:111], v[130:131], v[142:143]
    v_pk_mul_f32 v[112:113], v[130:131], v[144:145]
    v_pk_mul_f32 v[114:115], v[130:131], v[146:147]
    s_waitcnt lgkmcnt(0)
    v_pk_fma_f32 v[100:101], v[128:129], v[134:135], v[100:101]
    v_pk_fma_f32 v[102:103], v[128:129], v[136:137], v[102:103]
    v_pk_fma_f32 v[104:105], v[128:129], v[138:139], v[104:105]
    v_pk_fma_f32 v[106:107], v[128:129], v[140:141], v[106:107]
    v_pk_fma_f32 v[108:109], v[128:129], v[142:143], v[108:109]
    v_pk_fma_f32 v[110:111], v[128:129], v[144:145], v[110:111]
    v_pk_fma_f32 v[112:113], v[128:129], v[146:147], v[112:113]
    v_pk_fma_f32 v[114:115], v[128:129], v[148:149], v[114:115]
    v_pk_fma_f32 v[100:101], v[126:127], v[136:137], v[100:101]
    v_pk_fma_f32 v[102:103], v[126:127], v[138:139], v[102:103]
    v_pk_fma_f32 v[104:105], v[126:127], v[140:141], v[104:105]
    v_pk_fma_f32 v[106:107], v[126:127], v[142:143], v[106:107]
    v_pk_fma_f32 v[108:109], v[126:127], v[144:145], v[108:109]
    v_pk_fma_f32 v[110:111], v[126:127], v[146:147], v[110:111]
    v_pk_fma_f32 v[112:113], v[126:127], v[148:149], v[112:113]
    v_pk_fma_f32 v[114:115], v[126:127], v[150:151], v[114:115]
    v_pk_fma_f32 v[100:101], v[124:125], v[138:139], v[100:101]
    v_pk_fma_f32 v[102:103], v[124:125], v[140:141], v[102:103]
    v_pk_fma_f32 v[104:105], v[124:125], v[142:143], v[104:105]
    v_pk_fma_f32 v[106:107], v[124:125], v[144:145], v[106:107]
    v_pk_fma_f32 v[108:109], v[124:125], v[146:147], v[108:109]
    v_pk_fma_f32 v[110:111], v[124:125], v[148:149], v[110:111]
    v_pk_fma_f32 v[112:113], v[124:125], v[150:151], v[112:113]
    v_pk_fma_f32 v[114:115], v[124:125], v[152:153], v[114:115]
    v_lshlrev_b32 v132, 16, v116
    v_and_b32 v133, v23, v116
    v_lshlrev_b32 v134, 16, v117
    v_and_b32 v135, v23, v117
    v_lshlrev_b32 v136, 16, v118
    v_and_b32 v137, v23, v118
    v_lshlrev_b32 v138, 16, v119
    v_and_b32 v139, v23, v119
    v_lshlrev_b32 v140, 16, v120
    v_and_b32 v141, v23, v120
    v_lshlrev_b32 v142, 16, v121
    v_and_b32 v143, v23, v121
    v_lshlrev_b32 v144, 16, v122
    v_and_b32 v145, v23, v122
    v_lshlrev_b32 v146, 16, v123
    v_and_b32 v147, v23, v123
    v_pk_mul_f32 v[100:101], v[100:101], v[132:133]
    v_pk_mul_f32 v[102:103], v[102:103], v[134:135]
    v_pk_mul_f32 v[104:105], v[104:105], v[136:137]
    v_pk_mul_f32 v[106:107], v[106:107], v[138:139]
    v_pk_mul_f32 v[108:109], v[108:109], v[140:141]
    v_pk_mul_f32 v[110:111], v[110:111], v[142:143]
    v_pk_mul_f32 v[112:113], v[112:113], v[144:145]
    v_pk_mul_f32 v[114:115], v[114:115], v[146:147]
    s_lshl_b32 s62, s94, 18
    s_lshl_b32 s63, s93, 7
    s_sub_u32 s62, s62, s63
    s_add_u32 s63, s62, 1052544
    s_lshl_b32 s62, s94, 5
    s_add_u32 s62, s62, s93
    s_lshl_b32 s62, s62, 3
    s_add_u32 s88, s62, 720896
    v_cvt_pk_bf16_f32 v124, v114, v112
    v_cvt_pk_bf16_f32 v125, v110, v108
    v_cvt_pk_bf16_f32 v126, v106, v104
    v_cvt_pk_bf16_f32 v127, v102, v100
    v_cvt_pk_bf16_f32 v128, v115, v113
    v_cvt_pk_bf16_f32 v129, v111, v109
    v_cvt_pk_bf16_f32 v130, v107, v105
    v_cvt_pk_bf16_f32 v131, v103, v101
    buffer_store_dwordx4 v[124:127], v97, s[36:39], s63 offen sc1
    buffer_store_dwordx4 v[128:131], v96, s[36:39], s63 offen sc1
    s_waitcnt vmcnt(2)
    s_add_u32 s99, s99, 1
    v_mov_b32 v29, s99
    ds_write_b32 v27, v29
    v_and_b32 v30, 3, v1
    v_lshlrev_b32 v30, 2, v30
    v_and_b32 v31, -16, v27
    v_add_u32 v30, v30, v31
    s_mov_b32 s59, 1000000
L_qs_67:
    ds_read_b32 v29, v30
    s_waitcnt lgkmcnt(0)
    v_cmp_gt_u32 vcc, s99, v29
    s_cbranch_vccz L_qsd_68
    s_sleep 1
    s_sub_u32 s59, s59, 1
    s_cbranch_scc0 L_qs_67
L_qsd_68:
    v_and_b32 v164, 7, v0
    v_lshrrev_b32 v165, 5, v0
    v_bfe_u32 v166, v0, 3, 2
    v_xor_b32 v167, v165, v164
    v_lshlrev_b32 v167, 4, v167
    v_lshl_add_u32 v167, v166, 2, v167
    v_lshl_add_u32 v161, v164, 10, v167
    v_add_u32 v162, 56352, v161
    v_add_u32 v161, 47136, v161
    v_add_u32 v168, 1, v164
    v_and_b32 v169, 7, v168
    v_xor_b32 v169, v165, v169
    v_lshlrev_b32 v169, 4, v169
    v_lshl_add_u32 v169, v166, 2, v169
    v_lshl_add_u32 v160, v168, 10, v169
    v_add_u32 v160, 47136, v160
    ds_read2_b32 v[164:165], v161 offset0:128 offset1:160
    ds_read2_b32 v[166:167], v161 offset0:192 offset1:224
    ds_read2_b32 v[168:169], v160 offset0:0 offset1:32
    ds_read2_b32 v[170:171], v160 offset0:64 offset1:96
    ds_read2_b32 v[172:173], v160 offset0:128 offset1:160
    ds_read2_b32 v[174:175], v160 offset0:192 offset1:224
    ds_read2_b32 v[180:181], v162 offset0:0 offset1:32
    ds_read2_b32 v[182:183], v162 offset0:64 offset1:96
    ds_read2_b32 v[184:185], v162 offset0:128 offset1:160
    ds_read2_b32 v[186:187], v162 offset0:192 offset1:224
    v_mov_b32 v23, 0xffff0000
    v_lshlrev_b32 v188, 16, v56
    v_lshlrev_b32 v189, 16, v58
    v_and_b32 v190, v23, v56
    v_and_b32 v191, v23, v58
    v_lshlrev_b32 v192, 16, v57
    v_lshlrev_b32 v193, 16, v59
    v_and_b32 v194, v23, v57
    v_and_b32 v195, v23, v59
    v_and_b32 v161, 7, v0
    v_sub_u32 v161, 7, v161
    v_lshlrev_b32 v161, 4, v161
    v_lshrrev_b32 v160, 3, v0
    v_lshl_add_u32 v161, v160, 13, v161
    v_add_u32 v160, 4096, v161
    s_waitcnt lgkmcnt(4)
    v_lshlrev_b32 v196, 16, v165
    v_and_b32 v197, v23, v165
    v_lshlrev_b32 v198, 16, v166
    v_and_b32 v199, v23, v166
    v_lshlrev_b32 v200, 16, v167
    v_and_b32 v201, v23, v167
    v_lshlrev_b32 v202, 16, v168
    v_and_b32 v203, v23, v168
    v_lshlrev_b32 v204, 16, v169
    v_and_b32 v205, v23, v169
    v_lshlrev_b32 v206, 16, v170
    v_and_b32 v207, v23, v170
    v_lshlrev_b32 v208, 16, v171
    v_and_b32 v209, v23, v171
    v_lshlrev_b32 v210, 16, v172
    v_and_b32 v211, v23, v172
    v_lshlrev_b32 v212, 16, v173
    v_and_b32 v213, v23, v173
    v_lshlrev_b32 v214, 16, v174
    v_and_b32 v215, v23, v174
    v_lshlrev_b32 v216, 16, v175
    v_and_b32 v217, v23, v175
    v_pk_mul_f32 v[164:165], v[194:195], v[196:197]
    v_pk_mul_f32 v[166:167], v[194:195], v[198:199]
    v_pk_mul_f32 v[168:169], v[194:195], v[200:201]
    v_pk_mul_f32 v[170:171], v[194:195], v[202:203]
    v_pk_mul_f32 v[172:173], v[194:195], v[204:205]
    v_pk_mul_f32 v[174:175], v[194:195], v[206:207]
    v_pk_mul_f32 v[176:177], v[194:195], v[208:209]
    v_pk_mul_f32 v[178:179], v[194:195], v[210:211]
    s_waitcnt lgkmcnt(0)
    v_pk_fma_f32 v[164:165], v[192:193], v[198:199], v[164:165]
    v_pk_fma_f32 v[166:167], v[192:193], v[200:201], v[166:167]
    v_pk_fma_f32 v[168:169], v[192:193], v[202:203], v[168:169]
    v_pk_fma_f32 v[170:171], v[192:193], v[204:205], v[170:171]
    v_pk_fma_f32 v[172:173], v[192:193], v[206:207], v[172:173]
    v_pk_fma_f32 v[174:175], v[192:193], v[208:209], v[174:175]
    v_pk_fma_f32 v[176:177], v[192:193], v[210:211], v[176:177]
    v_pk_fma_f32 v[178:179], v[192:193], v[212:213], v[178:179]
    v_pk_fma_f32 v[164:165], v[190:191], v[200:201], v[164:165]
    v_pk_fma_f32 v[166:167], v[190:191], v[202:203], v[166:167]
    v_pk_fma_f32 v[168:169], v[190:191], v[204:205], v[168:169]
    v_pk_fma_f32 v[170:171], v[190:191], v[206:207], v[170:171]
    v_pk_fma_f32 v[172:173], v[190:191], v[208:209], v[172:173]
    v_pk_fma_f32 v[174:175], v[190:191], v[210:211], v[174:175]
    v_pk_fma_f32 v[176:177], v[190:191], v[212:213], v[176:177]
    v_pk_fma_f32 v[178:179], v[190:191], v[214:215], v[178:179]
    v_pk_fma_f32 v[164:165], v[188:189], v[202:203], v[164:165]
    v_pk_fma_f32 v[166:167], v[188:189], v[204:205], v[166:167]
    v_pk_fma_f32 v[168:169], v[188:189], v[206:207], v[168:169]
    v_pk_fma_f32 v[170:171], v[188:189], v[208:209], v[170:171]
    v_pk_fma_f32 v[172:173], v[188:189], v[210:211], v[172:173]
    v_pk_fma_f32 v[174:175], v[188:189], v[212:213], v[174:175]
    v_pk_fma_f32 v[176:177], v[188:189], v[214:215], v[176:177]
    v_pk_fma_f32 v[178:179], v[188:189], v[216:217], v[178:179]
    v_lshlrev_b32 v196, 16, v180
    v_and_b32 v197, v23, v180
    v_lshlrev_b32 v198, 16, v181
    v_and_b32 v199, v23, v181
    v_lshlrev_b32 v200, 16, v182
    v_and_b32 v201, v23, v182
    v_lshlrev_b32 v202, 16, v183
    v_and_b32 v203, v23, v183
    v_lshlrev_b32 v204, 16, v184
    v_and_b32 v205, v23, v184
    v_lshlrev_b32 v206, 16, v185
    v_and_b32 v207, v23, v185
    v_lshlrev_b32 v208, 16, v186
    v_and_b32 v209, v23, v186
    v_lshlrev_b32 v210, 16, v187
    v_and_b32 v211, v23, v187
    v_pk_mul_f32 v[164:165], v[164:165], v[196:197]
    v_pk_mul_f32 v[166:167], v[166:167], v[198:199]
    v_pk_mul_f32 v[168:169], v[168:169], v[200:201]
    v_pk_mul_f32 v[170:171], v[170:171], v[202:203]
    v_pk_mul_f32 v[172:173], v[172:173], v[204:205]
    v_pk_mul_f32 v[174:175], v[174:175], v[206:207]
    v_pk_mul_f32 v[176:177], v[176:177], v[208:209]
    v_pk_mul_f32 v[178:179], v[178:179], v[210:211]
    s_lshl_b32 s62, s5, 18
    s_lshl_b32 s63, s93, 7
    s_sub_u32 s62, s62, s63
    s_add_u32 s63, s62, 1052544
    s_lshl_b32 s62, s5, 5
    s_add_u32 s62, s62, s93
    s_lshl_b32 s62, s62, 3
    s_add_u32 s89, s62, 720896
    v_cvt_pk_bf16_f32 v188, v178, v176
    v_cvt_pk_bf16_f32 v189, v174, v172
    v_cvt_pk_bf16_f32 v190, v170, v168
    v_cvt_pk_bf16_f32 v191, v166, v164
    v_cvt_pk_bf16_f32 v192, v179, v177
    v_cvt_pk_bf16_f32 v193, v175, v173
    v_cvt_pk_bf16_f32 v194, v171, v169
    v_cvt_pk_bf16_f32 v195, v167, v165
    buffer_store_dwordx4 v[188:191], v161, s[36:39], s63 offen sc1
    buffer_store_dwordx4 v[192:195], v160, s[36:39], s63 offen sc1
    s_barrier
    s_and_b32 s60, s52, 1
    s_mul_i32 s61, s60, 8448
    s_add_u32 s95, s61, 98304
    s_add_u32 s18, s61, 115264
    s_mul_i32 s61, s60, 4608
    s_add_u32 s92, s61, 132352
    s_lshl_b32 s58, s2, 1
    s_add_u32 s58, s58, s60
    s_add_u32 s58, s58, 128
    s_mov_b32 s98, 141568
    s_mov_b32 s19, 86016
    s_lshr_b32 s60, s58, 6
    s_min_u32 s60, s60, 9
    s_lshl_b32 s60, s60, 8
    s_add_u32 s60, s60, 720896
    v_and_b32 v12, 31, v1
    v_lshl_add_u32 v12, v12, 3, s60
    s_waitcnt vmcnt(0)
    s_add_u32 s99, s99, 1
    v_mov_b32 v29, s99
    ds_write_b32 v27, v29
    v_and_b32 v30, 3, v1
    v_lshlrev_b32 v30, 2, v30
    v_and_b32 v31, -16, v27
    v_add_u32 v30, v30, v31
    s_mov_b32 s59, 1000000
L_qs_69:
    ds_read_b32 v29, v30
    s_waitcnt lgkmcnt(0)
    v_cmp_gt_u32 vcc, s99, v29
    s_cbranch_vccz L_qsd_70
    s_sleep 1
    s_sub_u32 s59, s59, 1
    s_cbranch_scc0 L_qs_69
L_qsd_70:
    s_cmp_eq_u32 s52, 0
    s_mov_b64 exec, 1
    s_cselect_b32 s60, s88, 0x80000000
    buffer_store_dwordx2 v[24:25], v26, s[36:39], s60 offen sc1
    s_cselect_b32 s60, s89, 0x80000000
    buffer_store_dwordx2 v[24:25], v26, s[36:39], s60 offen sc1
    s_mov_b64 exec, -1
    s_lshl_b32 s96, s58, 12
    s_lshr_b32 s6, s52, 1
    s_mul_i32 s60, s6, 4224
    s_add_u32 s60, s60, s95
    s_add_u32 m0, s60, 32
    s_lshl_b32 s61, s6, 2
    s_add_u32 s61, s61, s96
    v_add_u32 v16, s60, v2
    buffer_load_dwordx4 v2, s[20:23], s61 offen offset:0 nt lds
    buffer_load_dwordx4 v2, s[20:23], s61 offen offset:1024 nt lds
    buffer_load_dwordx4 v2, s[20:23], s61 offen offset:2048 nt lds
    buffer_load_dwordx4 v2, s[20:23], s61 offen offset:3072 nt lds
    v_lshrrev_b32 v6, 4, v1
    v_and_b32 v7, 15, v1
    v_add_u32 v33, v6, v7
    v_subrev_u32 v33, 16, v33
    v_lshlrev_b32 v33, 1, v33
    v_cmp_gt_i32 vcc, 0, v33
    v_mov_b32 v34, 0x80000000
    s_lshl_b32 s61, s58, 1
    v_cndmask_b32 v33, v33, v34, vcc
    buffer_load_ushort v34, v33, s[20:23], s96 offen
    s_cmp_eq_u32 s6, 0
    s_cselect_b32 s61, s61, 0x80000000
    buffer_load_ushort v35, v26, s[44:47], s61 offen
    s_sub_u32 s60, s18, s95
    v_and_b32 v19, 1, v6
    v_mul_lo_u32 v19, v19, s60
    v_lshrrev_b32 v9, 1, v6
    v_mul_u32_u24 v9, 4224, v9
    v_add3_u32 v9, v9, v19, s95
    v_lshl_add_u32 v9, v7, 1, v9
    s_waitcnt vmcnt(0)
    ds_write_b16 v9, v34
    ds_read_b128 v[64:67], v16 offset:32
    ds_read_b32 v68, v16 offset:48
    ds_read_b128 v[72:75], v16 offset:1056
    ds_read_b32 v76, v16 offset:1072
    ds_read_b128 v[80:83], v16 offset:2080
    ds_read_b32 v84, v16 offset:2096
    ds_read_b128 v[88:91], v16 offset:3104
    ds_read_b32 v92, v16 offset:3120
    v_add_u32 v8, 1, v7
    v_and_b32 v8, 3, v8
    v_lshl_add_u32 v17, v6, 3, v7
    v_sub_u32 v17, v17, v8
    v_lshlrev_b32 v17, 1, v17
    s_sub_u32 s60, s18, s95
    v_and_b32 v19, 1, v8
    v_mul_lo_u32 v19, v19, s60
    v_lshrrev_b32 v9, 1, v8
    v_mul_u32_u24 v9, 4224, v9
    v_add3_u32 v9, v9, v19, s95
    v_add_u32 v15, s60, v16
    s_lshl_b32 s61, s6, 8
    v_add3_u32 v17, v17, v9, s61
    s_add_u32 s61, s61, s92
    v_add_u32 v17, 2, v17
    v_lshlrev_b32 v18, 5, v7
    v_sub_u32 v18, 480, v18
    v_lshl_add_u32 v18, v6, 4, v18
    v_add_u32 v18, s61, v18
    v_lshl_add_u32 v8, v6, 3, v7
    v_sub_u32 v8, 15, v8
    v_and_b32 v19, 1, v8
    v_lshlrev_b32 v19, 4, v19
    v_lshlrev_b32 v19, v19, v35
    v_ashrrev_i32 v8, 1, v8
    v_cmp_eq_u32 vcc, 0, v8
    s_nop 1
    v_cndmask_b32 v20, 0, v19, vcc
    v_cmp_eq_u32 vcc, 1, v8
    s_nop 1
    v_cndmask_b32 v21, 0, v19, vcc
    v_cmp_eq_u32 vcc, 2, v8
    s_nop 1
    v_cndmask_b32 v22, 0, v19, vcc
    v_cmp_eq_u32 vcc, 3, v8
    s_nop 1
    v_cndmask_b32 v23, 0, v19, vcc
    s_waitcnt lgkmcnt(6)
    v_alignbit_b32 v96, v65, v64, 16
    v_alignbit_b32 v97, v66, v65, 16
    v_alignbit_b32 v98, v67, v66, 16
    v_alignbit_b32 v99, v68, v67, 16
    ds_write_b128 v15, v[96:99] offset:32
    s_waitcnt lgkmcnt(5)
    v_alignbit_b32 v100, v73, v72, 16
    v_alignbit_b32 v101, v74, v73, 16
    v_alignbit_b32 v102, v75, v74, 16
    v_alignbit_b32 v103, v76, v75, 16
    ds_write_b128 v15, v[100:103] offset:1056
    s_waitcnt lgkmcnt(4)
    v_alignbit_b32 v104, v81, v80, 16
    v_alignbit_b32 v105, v82, v81, 16
    v_alignbit_b32 v106, v83, v82, 16
    v_alignbit_b32 v107, v84, v83, 16
    ds_write_b128 v15, v[104:107] offset:2080
    s_waitcnt lgkmcnt(3)
    v_alignbit_b32 v108, v89, v88, 16
    v_alignbit_b32 v109, v90, v89, 16
    v_alignbit_b32 v110, v91, v90, 16
    v_alignbit_b32 v111, v92, v91, 16
    ds_write_b128 v15, v[108:111] offset:3104
    s_sleep 16
    s_cmp_lg_u32 s52, 0
    s_cbranch_scc1 L_o0_71
    v_mov_b32 v226, s48
    v_mov_b32 v227, s49
    s_mov_b32 exec_lo, 4294967295
    s_mov_b32 exec_hi, 0
    v_mov_b32 v226, 0
    v_mov_b32 v227, 0
    buffer_atomic_or_x2 v[226:227], v12, s[36:39], 0 offen sc0 sc1
    s_mov_b64 exec, -1
    s_waitcnt vmcnt(0)
    v_cmp_ne_u64 vcc, s[48:49], v[226:227]
    s_cbranch_vccz L_polld_kvs_73
    s_mov_b32 s59, 20000
L_poll_kvs_72:
    s_sleep 6
    v_mov_b32 v226, s48
    v_mov_b32 v227, s49
    s_mov_b32 exec_lo, 4294967295
    s_mov_b32 exec_hi, 0
    v_mov_b32 v226, 0
    v_mov_b32 v227, 0
    buffer_atomic_or_x2 v[226:227], v12, s[36:39], 0 offen sc0 sc1
    s_mov_b64 exec, -1
    s_waitcnt vmcnt(0)
    v_cmp_ne_u64 vcc, s[48:49], v[226:227]
    s_cbranch_vccz L_polld_kvs_73
    s_sub_u32 s59, s59, 1
    s_cbranch_scc0 L_poll_kvs_72
L_polld_kvs_73:
L_o0_71:
    s_add_u32 s99, s99, 1
    v_mov_b32 v29, s99
    ds_write_b32 v27, v29
    v_and_b32 v30, 3, v1
    v_lshlrev_b32 v30, 2, v30
    v_and_b32 v31, -16, v27
    v_add_u32 v30, v30, v31
    s_mov_b32 s59, 1000000
L_qs_74:
    ds_read_b32 v29, v30
    s_waitcnt lgkmcnt(0)
    v_cmp_gt_u32 vcc, s99, v29
    s_cbranch_vccz L_qsd_75
    s_sleep 1
    s_sub_u32 s59, s59, 1
    s_cbranch_scc0 L_qs_74
L_qsd_75:
    s_add_u32 s60, s96, 1048576
    s_mov_b32 m0, s92
    v_mov_b32 v14, 0
    v_mov_b32 v15, 0
    v_lshlrev_b32 v8, 3, v1
    v_add_u32 v8, s92, v8
    ds_write_b64 v8, v[14:15] offset:4096
    buffer_load_dwordx4 v2, s[36:39], s60 offen offset:0 sc1 lds
    buffer_load_dwordx4 v2, s[36:39], s60 offen offset:1024 sc1 lds
    buffer_load_dwordx4 v2, s[36:39], s60 offen offset:2048 sc1 lds
    buffer_load_dwordx4 v2, s[36:39], s60 offen offset:3072 sc1 lds
    s_lshl_b32 s60, s2, 2
    s_add_u32 s60, s60, s52
    s_cmp_lg_u32 s60, 1021
    s_cbranch_scc1 L_noep
    v_lshlrev_b32 v12, 7, v1
    v_add_u32 v12, 196608, v12
    s_mov_b32 s62, 0
    buffer_load_dwordx2 v[40:41], v12, s[36:39], s62 offen sc1
    s_mov_b32 s62, 8192
    buffer_load_dwordx2 v[42:43], v12, s[36:39], s62 offen sc1
    s_mov_b32 s62, 16384
    buffer_load_dwordx2 v[44:45], v12, s[36:39], s62 offen sc1
    s_mov_b32 s62, 24576
    buffer_load_dwordx2 v[46:47], v12, s[36:39], s62 offen sc1
    s_mov_b32 s59, 20000
    s_waitcnt vmcnt(0)
L_chk_ep_76:
    v_cmp_ne_u64 s[60:61], s[48:49], v[40:41]
    v_cmp_ne_u64 vcc, s[48:49], v[42:43]
    s_or_b64 s[60:61], s[60:61], vcc
    v_cmp_ne_u64 vcc, s[48:49], v[44:45]
    s_or_b64 s[60:61], s[60:61], vcc
    v_cmp_ne_u64 vcc, s[48:49], v[46:47]
    s_or_b64 s[60:61], s[60:61], vcc
    s_cmp_eq_u64 s[60:61], 0
    s_cbranch_scc1 L_chkok_ep_77
    s_sub_u32 s59, s59, 1
    s_cbranch_scc1 L_chkok_ep_77
    s_sleep 6
    s_mov_b32 s62, 0
    buffer_load_dwordx2 v[40:41], v12, s[36:39], s62 offen sc1
    s_mov_b32 s62, 8192
    buffer_load_dwordx2 v[42:43], v12, s[36:39], s62 offen sc1
    s_mov_b32 s62, 16384
    buffer_load_dwordx2 v[44:45], v12, s[36:39], s62 offen sc1
    s_mov_b32 s62, 24576
    buffer_load_dwordx2 v[46:47], v12, s[36:39], s62 offen sc1
    s_waitcnt vmcnt(0)
    s_branch L_chk_ep_76
L_chkok_ep_77:
    s_mov_b64 exec, 1
    buffer_store_dwordx2 v[24:25], v26, s[36:39], 0 offen sc1
    s_mov_b64 exec, -1
L_noep:
    s_waitcnt vmcnt(0) lgkmcnt(0)
    s_branch L_lconv
L_pc6:
    s_mul_i32 s60, s57, 5
    s_lshr_b32 s60, s60, 2
    s_lshl_b32 s60, s60, 8
    s_add_u32 s60, s60, 786432
    s_mul_i32 s61, s97, 13
    v_and_b32 v11, 31, v1
    v_min_u32 v11, 13, v11
    v_add_u32 v11, s61, v11
    v_and_b32 v29, 32, v1
    v_add_u32 v11, v11, v29
    v_lshl_add_u32 v11, v11, 3, s60
    s_cmp_lg_u32 s52, 0
    s_cbranch_scc1 L_o0_78
    v_mov_b32 v228, s48
    v_mov_b32 v229, s49
    s_mov_b32 exec_lo, 16383
    s_mov_b32 exec_hi, 16383
    v_mov_b32 v228, 0
    v_mov_b32 v229, 0
    buffer_atomic_or_x2 v[228:229], v11, s[36:39], 0 offen sc0 sc1
    s_mov_b64 exec, -1
    s_waitcnt vmcnt(0)
    v_cmp_ne_u64 vcc, s[48:49], v[228:229]
    s_cbranch_vccz L_polld_w2s_80
    s_mov_b32 s59, 20000
L_poll_w2s_79:
    s_sleep 6
    v_mov_b32 v228, s48
    v_mov_b32 v229, s49
    s_mov_b32 exec_lo, 16383
    s_mov_b32 exec_hi, 16383
    v_mov_b32 v228, 0
    v_mov_b32 v229, 0
    buffer_atomic_or_x2 v[228:229], v11, s[36:39], 0 offen sc0 sc1
    s_mov_b64 exec, -1
    s_waitcnt vmcnt(0)
    v_cmp_ne_u64 vcc, s[48:49], v[228:229]
    s_cbranch_vccz L_polld_w2s_80
    s_sub_u32 s59, s59, 1
    s_cbranch_scc0 L_poll_w2s_79
L_polld_w2s_80:
    v_mov_b32 v4, 163824
    v_mov_b32 v30, 1
    ds_max_u32 v4, v30
L_o0_78:
    s_mul_i32 s60, s57, 276480
    s_mul_i32 s61, s97, 138240
    s_add_u32 s60, s60, s61
    s_add_u32 s60, s60, 6291456
    s_add_u32 s28, s36, s60
    s_addc_u32 s29, s37, 0
    s_mov_b32 s30, 138240
    s_mov_b32 s31, 0x20000
    s_mul_i32 s61, s97, 110592
    s_add_u32 s61, s61, 8519680
    s_mul_i32 s60, s56, 221184
    s_add_u32 s60, s60, s61
    s_add_u32 s12, s36, s60
    s_addc_u32 s13, s37, 0
    s_mov_b32 s14, 110592
    s_mov_b32 s15, 0x20000
    s_xor_b32 s60, s56, 1
    s_mul_i32 s60, s60, 221184
    s_add_u32 s60, s60, s61
    s_add_u32 s40, s36, s60
    s_addc_u32 s41, s37, 0
    s_mov_b32 s42, 110592
    s_mov_b32 s43, 0x20000
    s_mul_i32 s16, s52, 28672
    s_mul_i32 s23, s52, 35840
    s_add_u32 s17, s16, 4096
    s_add_u32 s18, s16, 8192
    s_add_u32 s19, s16, 12288
    s_add_u32 s20, s16, 16384
    s_add_u32 s21, s16, 20480
    s_add_u32 s22, s16, 24576
    s_mov_b32 s90, s91
    s_mov_b32 s95, 100
    s_mov_b32 s98, 0
    s_branch L_g2c
L_pl:
    s_add_u32 s5, s93, 256
    s_lshl_b32 s58, s93, 2
    s_add_u32 s58, s58, s52
    s_mul_i32 s95, s52, 21504
    s_add_u32 s92, s95, 16640
    s_waitcnt vmcnt(2)
    s_mul_i32 s60, s2, 6554
    s_lshr_b32 s60, s60, 16
    s_mul_i32 s61, s60, 10
    s_sub_u32 s61, s2, s61
    s_mul_i32 s60, s60, 81920
    s_lshl_b32 s61, s61, 7
    s_add_u32 s60, s60, s61
    s_mul_i32 s61, s52, 20480
    s_add_u32 s60, s60, s61
    v_lshrrev_b32 v4, 3, v1
    v_mul_u32_u24 v4, 1280, v4
    v_and_b32 v5, 7, v1
    v_lshl_add_u32 v4, v5, 4, v4
    s_lshl_b32 s61, s52, 11
    s_add_u32 m0, s61, 86016
    v_add_u32 v5, 9216, v4
    buffer_load_dwordx4 v4, s[28:31], s60 offen nt lds
    buffer_load_dwordx4 v5, s[28:31], s60 offen offset:1024 nt lds
    s_mul_i32 s60, s5, 6554
    s_lshr_b32 s60, s60, 16
    s_mul_i32 s61, s60, 10
    s_sub_u32 s61, s5, s61
    s_mul_i32 s60, s60, 81920
    s_lshl_b32 s61, s61, 7
    s_add_u32 s60, s60, s61
    s_mul_i32 s61, s52, 20480
    s_add_u32 s60, s60, s61
    v_lshrrev_b32 v4, 3, v1
    v_mul_u32_u24 v4, 1280, v4
    v_and_b32 v5, 7, v1
    v_lshl_add_u32 v4, v5, 4, v4
    s_lshl_b32 s61, s52, 11
    s_add_u32 m0, s61, 68640
    v_add_u32 v5, 9216, v4
    buffer_load_dwordx4 v4, s[28:31], s60 offen nt lds
    buffer_load_dwordx4 v5, s[28:31], s60 offen offset:1024 nt lds
    s_waitcnt vmcnt(4)
    s_add_u32 s99, s99, 1
    v_mov_b32 v29, s99
    ds_write_b32 v27, v29
    v_and_b32 v30, 3, v1
    v_lshlrev_b32 v30, 2, v30
    v_and_b32 v31, -16, v27
    v_add_u32 v30, v30, v31
    s_mov_b32 s59, 1000000
L_qs_81:
    ds_read_b32 v29, v30
    s_waitcnt lgkmcnt(0)
    v_cmp_gt_u32 vcc, s99, v29
    s_cbranch_vccz L_qsd_82
    s_sleep 1
    s_sub_u32 s59, s59, 1
    s_cbranch_scc0 L_qs_81
L_qsd_82:
    s_lshl_b32 s96, s58, 12
    s_mov_b32 s6, 0
    s_mul_i32 s60, s6, 4224
    s_add_u32 s60, s60, s95
    s_add_u32 m0, s60, 32
    s_lshl_b32 s61, s6, 2
    s_add_u32 s61, s61, s96
    v_add_u32 v16, s60, v2
    buffer_load_dwordx4 v2, s[20:23], s61 offen offset:0 nt lds
    buffer_load_dwordx4 v2, s[20:23], s61 offen offset:1024 nt lds
    buffer_load_dwordx4 v2, s[20:23], s61 offen offset:2048 nt lds
    buffer_load_dwordx4 v2, s[20:23], s61 offen offset:3072 nt lds
    v_lshrrev_b32 v6, 4, v1
    v_and_b32 v7, 15, v1
    v_add_u32 v33, v6, v7
    v_subrev_u32 v33, 16, v33
    v_lshlrev_b32 v33, 1, v33
    v_cmp_gt_i32 vcc, 0, v33
    v_mov_b32 v34, 0x80000000
    s_lshl_b32 s61, s58, 1
    v_cndmask_b32 v33, v33, v34, vcc
    buffer_load_ushort v34, v33, s[20:23], s96 offen
    s_cmp_eq_u32 s6, 0
    s_cselect_b32 s61, s61, 0x80000000
    buffer_load_ushort v35, v26, s[44:47], s61 offen
    ds_read2_b32 v[100:101], v97 offset0:128 offset1:160
    ds_read2_b32 v[102:103], v97 offset0:192 offset1:224
    ds_read2_b32 v[104:105], v96 offset0:0 offset1:32
    ds_read2_b32 v[106:107], v96 offset0:64 offset1:96
    ds_read2_b32 v[108:109], v96 offset0:128 offset1:160
    ds_read2_b32 v[110:111], v96 offset0:192 offset1:224
    ds_read2_b32 v[116:117], v98 offset0:0 offset1:32
    ds_read2_b32 v[118:119], v98 offset0:64 offset1:96
    ds_read2_b32 v[120:121], v98 offset0:128 offset1:160
    ds_read2_b32 v[122:123], v98 offset0:192 offset1:224
    v_mov_b32 v23, 0xffff0000
    v_lshlrev_b32 v124, 16, v44
    v_lshlrev_b32 v125, 16, v46
    v_and_b32 v126, v23, v44
    v_and_b32 v127, v23, v46
    v_lshlrev_b32 v128, 16, v45
    v_lshlrev_b32 v129, 16, v47
    v_and_b32 v130, v23, v45
    v_and_b32 v131, v23, v47
    v_and_b32 v97, 7, v0
    v_sub_u32 v97, 7, v97
    v_lshlrev_b32 v97, 4, v97
    v_lshrrev_b32 v96, 3, v0
    v_lshl_add_u32 v97, v96, 13, v97
    v_add_u32 v96, 4096, v97
    s_waitcnt lgkmcnt(4)
    v_lshlrev_b32 v132, 16, v101
    v_and_b32 v133, v23, v101
    v_lshlrev_b32 v134, 16, v102
    v_and_b32 v135, v23, v102
    v_lshlrev_b32 v136, 16, v103
    v_and_b32 v137, v23, v103
    v_lshlrev_b32 v138, 16, v104
    v_and_b32 v139, v23, v104
    v_lshlrev_b32 v140, 16, v105
    v_and_b32 v141, v23, v105
    v_lshlrev_b32 v142, 16, v106
    v_and_b32 v143, v23, v106
    v_lshlrev_b32 v144, 16, v107
    v_and_b32 v145, v23, v107
    v_lshlrev_b32 v146, 16, v108
    v_and_b32 v147, v23, v108
    v_lshlrev_b32 v148, 16, v109
    v_and_b32 v149, v23, v109
    v_lshlrev_b32 v150, 16, v110
    v_and_b32 v151, v23, v110
    v_lshlrev_b32 v152, 16, v111
    v_and_b32 v153, v23, v111
    v_pk_mul_f32 v[100:101], v[130:131], v[132:133]
    v_pk_mul_f32 v[102:103], v[130:131], v[134:135]
    v_pk_mul_f32 v[104:105], v[130:131], v[136:137]
    v_pk_mul_f32 v[106:107], v[130:131], v[138:139]
    v_pk_mul_f32 v[108:109], v[130:131], v[140:141]
    v_pk_mul_f32 v[110:111], v[130:131], v[142:143]
    v_pk_mul_f32 v[112:113], v[130:131], v[144:145]
    v_pk_mul_f32 v[114:115], v[130:131], v[146:147]
    s_waitcnt lgkmcnt(0)
    v_pk_fma_f32 v[100:101], v[128:129], v[134:135], v[100:101]
    v_pk_fma_f32 v[102:103], v[128:129], v[136:137], v[102:103]
    v_pk_fma_f32 v[104:105], v[128:129], v[138:139], v[104:105]
    v_pk_fma_f32 v[106:107], v[128:129], v[140:141], v[106:107]
    v_pk_fma_f32 v[108:109], v[128:129], v[142:143], v[108:109]
    v_pk_fma_f32 v[110:111], v[128:129], v[144:145], v[110:111]
    v_pk_fma_f32 v[112:113], v[128:129], v[146:147], v[112:113]
    v_pk_fma_f32 v[114:115], v[128:129], v[148:149], v[114:115]
    v_pk_fma_f32 v[100:101], v[126:127], v[136:137], v[100:101]
    v_pk_fma_f32 v[102:103], v[126:127], v[138:139], v[102:103]
    v_pk_fma_f32 v[104:105], v[126:127], v[140:141], v[104:105]
    v_pk_fma_f32 v[106:107], v[126:127], v[142:143], v[106:107]
    v_pk_fma_f32 v[108:109], v[126:127], v[144:145], v[108:109]
    v_pk_fma_f32 v[110:111], v[126:127], v[146:147], v[110:111]
    v_pk_fma_f32 v[112:113], v[126:127], v[148:149], v[112:113]
    v_pk_fma_f32 v[114:115], v[126:127], v[150:151], v[114:115]
    v_pk_fma_f32 v[100:101], v[124:125], v[138:139], v[100:101]
    v_pk_fma_f32 v[102:103], v[124:125], v[140:141], v[102:103]
    v_pk_fma_f32 v[104:105], v[124:125], v[142:143], v[104:105]
    v_pk_fma_f32 v[106:107], v[124:125], v[144:145], v[106:107]
    v_pk_fma_f32 v[108:109], v[124:125], v[146:147], v[108:109]
    v_pk_fma_f32 v[110:111], v[124:125], v[148:149], v[110:111]
    v_pk_fma_f32 v[112:113], v[124:125], v[150:151], v[112:113]
    v_pk_fma_f32 v[114:115], v[124:125], v[152:153], v[114:115]
    v_lshlrev_b32 v132, 16, v116
    v_and_b32 v133, v23, v116
    v_lshlrev_b32 v134, 16, v117
    v_and_b32 v135, v23, v117
    v_lshlrev_b32 v136, 16, v118
    v_and_b32 v137, v23, v118
    v_lshlrev_b32 v138, 16, v119
    v_and_b32 v139, v23, v119
    v_lshlrev_b32 v140, 16, v120
    v_and_b32 v141, v23, v120
    v_lshlrev_b32 v142, 16, v121
    v_and_b32 v143, v23, v121
    v_lshlrev_b32 v144, 16, v122
    v_and_b32 v145, v23, v122
    v_lshlrev_b32 v146, 16, v123
    v_and_b32 v147, v23, v123
    v_pk_mul_f32 v[100:101], v[100:101], v[132:133]
    v_pk_mul_f32 v[102:103], v[102:103], v[134:135]
    v_pk_mul_f32 v[104:105], v[104:105], v[136:137]
    v_pk_mul_f32 v[106:107], v[106:107], v[138:139]
    v_pk_mul_f32 v[108:109], v[108:109], v[140:141]
    v_pk_mul_f32 v[110:111], v[110:111], v[142:143]
    v_pk_mul_f32 v[112:113], v[112:113], v[144:145]
    v_pk_mul_f32 v[114:115], v[114:115], v[146:147]
    s_lshl_b32 s62, s94, 18
    s_lshl_b32 s63, s93, 7
    s_sub_u32 s62, s62, s63
    s_add_u32 s63, s62, 1052544
    s_lshl_b32 s62, s94, 5
    s_add_u32 s62, s62, s93
    s_lshl_b32 s62, s62, 3
    s_add_u32 s88, s62, 720896
    v_cvt_pk_bf16_f32 v124, v114, v112
    v_cvt_pk_bf16_f32 v125, v110, v108
    v_cvt_pk_bf16_f32 v126, v106, v104
    v_cvt_pk_bf16_f32 v127, v102, v100
    v_cvt_pk_bf16_f32 v128, v115, v113
    v_cvt_pk_bf16_f32 v129, v111, v109
    v_cvt_pk_bf16_f32 v130, v107, v105
    v_cvt_pk_bf16_f32 v131, v103, v101
    buffer_store_dwordx4 v[124:127], v97, s[36:39], s63 offen sc1
    buffer_store_dwordx4 v[128:131], v96, s[36:39], s63 offen sc1
    s_waitcnt vmcnt(8)
    s_add_u32 s99, s99, 1
    v_mov_b32 v29, s99
    ds_write_b32 v27, v29
    v_and_b32 v30, 3, v1
    v_lshlrev_b32 v30, 2, v30
    v_and_b32 v31, -16, v27
    v_add_u32 v30, v30, v31
    s_mov_b32 s59, 1000000
L_qs_83:
    ds_read_b32 v29, v30
    s_waitcnt lgkmcnt(0)
    v_cmp_gt_u32 vcc, s99, v29
    s_cbranch_vccz L_qsd_84
    s_sleep 1
    s_sub_u32 s59, s59, 1
    s_cbranch_scc0 L_qs_83
L_qsd_84:
    v_bfe_u32 v4, v1, 2, 2
    v_lshrrev_b32 v5, 4, v1
    v_lshl_add_u32 v4, v5, 2, v4
    v_lshlrev_b32 v4, 7, v4
    v_and_b32 v5, 3, v1
    v_lshl_add_u32 v4, v5, 3, v4
    s_lshr_b32 s60, s52, 1
    s_lshl_b32 s60, s60, 12
    s_and_b32 s61, s52, 1
    s_lshl_b32 s61, s61, 6
    s_add_u32 s60, s60, s61
    s_add_u32 s60, s60, 86016
    v_add_u32 v4, s60, v4
    ds_read_b64_tr_b16 v[48:49], v4 offset:0
    ds_read_b64_tr_b16 v[50:51], v4 offset:2048
    ds_read_b64_tr_b16 v[52:53], v4 offset:32
    ds_read_b64_tr_b16 v[54:55], v4 offset:2080
    v_bfe_u32 v4, v1, 2, 2
    v_lshrrev_b32 v5, 4, v1
    v_lshl_add_u32 v4, v5, 2, v4
    v_lshlrev_b32 v4, 7, v4
    v_and_b32 v5, 3, v1
    v_lshl_add_u32 v4, v5, 3, v4
    s_lshr_b32 s60, s52, 1
    s_lshl_b32 s60, s60, 12
    s_and_b32 s61, s52, 1
    s_lshl_b32 s61, s61, 6
    s_add_u32 s60, s60, s61
    s_add_u32 s60, s60, 68640
    v_add_u32 v4, s60, v4
    ds_read_b64_tr_b16 v[56:57], v4 offset:0
    ds_read_b64_tr_b16 v[58:59], v4 offset:2048
    ds_read_b64_tr_b16 v[60:61], v4 offset:32
    ds_read_b64_tr_b16 v[62:63], v4 offset:2080
    s_mul_i32 s60, s2, 6554
    s_lshr_b32 s60, s60, 16
    s_mul_i32 s61, s60, 10
    s_sub_u32 s61, s2, s61
    s_lshl_b32 s62, s61, 5
    s_add_u32 s62, s62, s60
    s_lshl_b32 s62, s62, 3
    s_add_u32 s89, s62, 786432
    s_lshl_b32 s60, s60, 1
    s_lshr_b32 s62, s52, 1
    s_add_u32 s60, s60, s62
    s_lshl_b32 s61, s61, 1
    s_and_b32 s62, s52, 1
    s_add_u32 s61, s61, s62
    s_mul_i32 s60, s60, 5120
    s_add_u32 s60, s60, 6291456
    s_lshl_b32 s61, s61, 1
    s_waitcnt lgkmcnt(0)
    s_add_u32 s62, s61, 0
    s_mul_i32 s63, s62, 52
    s_lshr_b32 s63, s63, 8
    s_mul_i32 s63, s63, 271360
    s_lshl_b32 s62, s62, 10
    s_add_u32 s63, s63, s62
    s_add_u32 s63, s63, s60
    buffer_store_dwordx4 v[48:51], v2, s[36:39], s63 offen sc1
    s_add_u32 s62, s61, 1
    s_mul_i32 s63, s62, 52
    s_lshr_b32 s63, s63, 8
    s_mul_i32 s63, s63, 271360
    s_lshl_b32 s62, s62, 10
    s_add_u32 s63, s63, s62
    s_add_u32 s63, s63, s60
    buffer_store_dwordx4 v[52:55], v2, s[36:39], s63 offen sc1
    s_mov_b32 s91, 0x80000000
    s_cmp_ge_u32 s5, 270
    s_cbranch_scc1 L_pl2
    s_mul_i32 s60, s5, 6554
    s_lshr_b32 s60, s60, 16
    s_mul_i32 s61, s60, 10
    s_sub_u32 s61, s5, s61
    s_lshl_b32 s62, s61, 5
    s_add_u32 s62, s62, s60
    s_lshl_b32 s62, s62, 3
    s_add_u32 s91, s62, 786432
    s_lshl_b32 s60, s60, 1
    s_lshr_b32 s62, s52, 1
    s_add_u32 s60, s60, s62
    s_lshl_b32 s61, s61, 1
    s_and_b32 s62, s52, 1
    s_add_u32 s61, s61, s62
    s_mul_i32 s60, s60, 5120
    s_add_u32 s60, s60, 6291456
    s_lshl_b32 s61, s61, 1
    s_waitcnt lgkmcnt(0)
    s_add_u32 s62, s61, 0
    s_mul_i32 s63, s62, 52
    s_lshr_b32 s63, s63, 8
    s_mul_i32 s63, s63, 271360
    s_lshl_b32 s62, s62, 10
    s_add_u32 s63, s63, s62
    s_add_u32 s63, s63, s60
    buffer_store_dwordx4 v[56:59], v2, s[36:39], s63 offen sc1
    s_add_u32 s62, s61, 1
    s_mul_i32 s63, s62, 52
    s_lshr_b32 s63, s63, 8
    s_mul_i32 s63, s63, 271360
    s_lshl_b32 s62, s62, 10
    s_add_u32 s63, s63, s62
    s_add_u32 s63, s63, s60
    buffer_store_dwordx4 v[60:63], v2, s[36:39], s63 offen sc1
L_pl2:
    s_barrier
    s_lshr_b32 s60, s58, 6
    s_min_u32 s60, s60, 9
    s_lshl_b32 s60, s60, 8
    s_add_u32 s60, s60, 720896
    v_and_b32 v12, 31, v1
    v_lshl_add_u32 v12, v12, 3, s60
    v_mul_u32_u24 v9, 4160, v6
    v_add_u32 v9, s95, v9
    v_lshl_add_u32 v9, v7, 1, v9
    s_waitcnt vmcnt(4)
    ds_write_b16 v9, v34
    ds_read_b128 v[64:67], v16 offset:32
    ds_read_b64 v[68:69], v16 offset:48
    ds_read_b128 v[72:75], v16 offset:1056
    ds_read_b64 v[76:77], v16 offset:1072
    ds_read_b128 v[80:83], v16 offset:2080
    ds_read_b64 v[84:85], v16 offset:2096
    ds_read_b128 v[88:91], v16 offset:3104
    ds_read_b64 v[92:93], v16 offset:3120
    v_add_u32 v8, 1, v7
    v_and_b32 v8, 3, v8
    v_lshl_add_u32 v17, v6, 3, v7
    v_sub_u32 v17, v17, v8
    v_lshlrev_b32 v17, 1, v17
    v_mul_u32_u24 v9, 4160, v8
    v_add_u32 v9, s95, v9
    s_lshl_b32 s61, s6, 8
    v_add3_u32 v17, v17, v9, s61
    s_add_u32 s61, s61, s92
    v_add_u32 v17, 2, v17
    v_lshlrev_b32 v18, 5, v7
    v_sub_u32 v18, 480, v18
    v_lshl_add_u32 v18, v6, 4, v18
    v_add_u32 v18, s61, v18
    v_lshl_add_u32 v8, v6, 3, v7
    v_sub_u32 v8, 15, v8
    v_and_b32 v19, 1, v8
    v_lshlrev_b32 v19, 4, v19
    v_lshlrev_b32 v19, v19, v35
    v_ashrrev_i32 v8, 1, v8
    v_cmp_eq_u32 vcc, 0, v8
    s_nop 1
    v_cndmask_b32 v20, 0, v19, vcc
    v_cmp_eq_u32 vcc, 1, v8
    s_nop 1
    v_cndmask_b32 v21, 0, v19, vcc
    v_cmp_eq_u32 vcc, 2, v8
    s_nop 1
    v_cndmask_b32 v22, 0, v19, vcc
    v_cmp_eq_u32 vcc, 3, v8
    s_nop 1
    v_cndmask_b32 v23, 0, v19, vcc
    s_waitcnt lgkmcnt(6)
    v_alignbit_b32 v96, v65, v64, 16
    v_alignbit_b32 v97, v66, v65, 16
    v_alignbit_b32 v98, v67, v66, 16
    v_alignbit_b32 v99, v68, v67, 16
    ds_write_b128 v16, v[96:99] offset:4192
    v_mov_b32 v128, v65
    v_alignbit_b32 v132, v66, v65, 16
    v_mov_b32 v129, v66
    v_alignbit_b32 v133, v67, v66, 16
    v_mov_b32 v130, v67
    v_alignbit_b32 v134, v68, v67, 16
    v_mov_b32 v131, v68
    v_alignbit_b32 v135, v69, v68, 16
    ds_write_b128 v16, v[128:131] offset:8352
    ds_write_b128 v16, v[132:135] offset:12512
    s_waitcnt lgkmcnt(7)
    v_alignbit_b32 v100, v73, v72, 16
    v_alignbit_b32 v101, v74, v73, 16
    v_alignbit_b32 v102, v75, v74, 16
    v_alignbit_b32 v103, v76, v75, 16
    ds_write_b128 v16, v[100:103] offset:5216
    v_mov_b32 v136, v73
    v_alignbit_b32 v140, v74, v73, 16
    v_mov_b32 v137, v74
    v_alignbit_b32 v141, v75, v74, 16
    v_mov_b32 v138, v75
    v_alignbit_b32 v142, v76, v75, 16
    v_mov_b32 v139, v76
    v_alignbit_b32 v143, v77, v76, 16
    ds_write_b128 v16, v[136:139] offset:9376
    ds_write_b128 v16, v[140:143] offset:13536
    s_waitcnt lgkmcnt(8)
    v_alignbit_b32 v104, v81, v80, 16
    v_alignbit_b32 v105, v82, v81, 16
    v_alignbit_b32 v106, v83, v82, 16
    v_alignbit_b32 v107, v84, v83, 16
    ds_write_b128 v16, v[104:107] offset:6240
    v_mov_b32 v144, v81
    v_alignbit_b32 v148, v82, v81, 16
    v_mov_b32 v145, v82
    v_alignbit_b32 v149, v83, v82, 16
    v_mov_b32 v146, v83
    v_alignbit_b32 v150, v84, v83, 16
    v_mov_b32 v147, v84
    v_alignbit_b32 v151, v85, v84, 16
    ds_write_b128 v16, v[144:147] offset:10400
    ds_write_b128 v16, v[148:151] offset:14560
    s_waitcnt lgkmcnt(9)
    v_alignbit_b32 v108, v89, v88, 16
    v_alignbit_b32 v109, v90, v89, 16
    v_alignbit_b32 v110, v91, v90, 16
    v_alignbit_b32 v111, v92, v91, 16
    ds_write_b128 v16, v[108:111] offset:7264
    v_mov_b32 v152, v89
    v_alignbit_b32 v156, v90, v89, 16
    v_mov_b32 v153, v90
    v_alignbit_b32 v157, v91, v90, 16
    v_mov_b32 v154, v91
    v_alignbit_b32 v158, v92, v91, 16
    v_mov_b32 v155, v92
    v_alignbit_b32 v159, v93, v92, 16
    ds_write_b128 v16, v[152:155] offset:11424
    ds_write_b128 v16, v[156:159] offset:15584
    s_waitcnt vmcnt(0)
    s_cmp_lg_u32 s52, 0
    s_cbranch_scc1 L_o0_85
    v_mov_b32 v226, s48
    v_mov_b32 v227, s49
    s_mov_b32 exec_lo, 4294967295
    s_mov_b32 exec_hi, 0
    v_mov_b32 v226, 0
    v_mov_b32 v227, 0
    buffer_atomic_or_x2 v[226:227], v12, s[36:39], 0 offen sc0 sc1
    s_mov_b64 exec, -1
L_o0_85:
    s_add_u32 s99, s99, 1
    v_mov_b32 v29, s99
    ds_write_b32 v27, v29
    v_and_b32 v30, 3, v1
    v_lshlrev_b32 v30, 2, v30
    v_and_b32 v31, -16, v27
    v_add_u32 v30, v30, v31
    s_mov_b32 s59, 1000000
L_qs_86:
    ds_read_b32 v29, v30
    s_waitcnt lgkmcnt(0)
    v_cmp_gt_u32 vcc, s99, v29
    s_cbranch_vccz L_qsd_87
    s_sleep 1
    s_sub_u32 s59, s59, 1
    s_cbranch_scc0 L_qs_86
L_qsd_87:
    s_lshl_b32 s61, s2, 7
    s_add_u32 s61, s61, 196608
    s_cmp_eq_u32 s52, 0
    s_mov_b64 exec, 1
    s_cselect_b32 s60, s88, 0x80000000
    buffer_store_dwordx2 v[24:25], v26, s[36:39], s60 offen sc1
    s_cselect_b32 s60, s89, 0x80000000
    buffer_store_dwordx2 v[24:25], v26, s[36:39], s60 offen sc1
    s_cselect_b32 s60, s91, 0x80000000
    buffer_store_dwordx2 v[24:25], v26, s[36:39], s60 offen sc1
    s_cselect_b32 s60, s61, 0x80000000
    buffer_store_dwordx2 v[24:25], v26, s[36:39], s60 offen sc1
    s_mov_b64 exec, -1
    s_cmp_lg_u32 s52, 0
    s_cbranch_scc1 L_o0_88
    s_waitcnt vmcnt(4)
    v_cmp_ne_u64 vcc, s[48:49], v[226:227]
    s_cbranch_vccz L_polld_kvl_90
    s_mov_b32 s59, 20000
L_poll_kvl_89:
    s_sleep 6
    v_mov_b32 v226, s48
    v_mov_b32 v227, s49
    s_mov_b32 exec_lo, 4294967295
    s_mov_b32 exec_hi, 0
    v_mov_b32 v226, 0
    v_mov_b32 v227, 0
    buffer_atomic_or_x2 v[226:227], v12, s[36:39], 0 offen sc0 sc1
    s_mov_b64 exec, -1
    s_waitcnt vmcnt(0)
    v_cmp_ne_u64 vcc, s[48:49], v[226:227]
    s_cbranch_vccz L_polld_kvl_90
    s_sub_u32 s59, s59, 1
    s_cbranch_scc0 L_poll_kvl_89
L_polld_kvl_90:
L_o0_88:
    s_add_u32 s99, s99, 1
    v_mov_b32 v29, s99
    ds_write_b32 v27, v29
    v_and_b32 v30, 3, v1
    v_lshlrev_b32 v30, 2, v30
    v_and_b32 v31, -16, v27
    v_add_u32 v30, v30, v31
    s_mov_b32 s59, 1000000
L_qs_91:
    ds_read_b32 v29, v30
    s_waitcnt lgkmcnt(0)
    v_cmp_gt_u32 vcc, s99, v29
    s_cbranch_vccz L_qsd_92
    s_sleep 1
    s_sub_u32 s59, s59, 1
    s_cbranch_scc0 L_qs_91
L_qsd_92:
    s_add_u32 s60, s96, 1048576
    s_mov_b32 m0, s92
    v_mov_b32 v14, 0
    v_mov_b32 v15, 0
    v_lshlrev_b32 v8, 3, v1
    v_add_u32 v8, s92, v8
    ds_write_b64 v8, v[14:15] offset:4096
    buffer_load_dwordx4 v2, s[36:39], s60 offen offset:0 sc1 lds
    buffer_load_dwordx4 v2, s[36:39], s60 offen offset:1024 sc1 lds
    buffer_load_dwordx4 v2, s[36:39], s60 offen offset:2048 sc1 lds
    buffer_load_dwordx4 v2, s[36:39], s60 offen offset:3072 sc1 lds
    s_waitcnt vmcnt(0) lgkmcnt(0)
    ds_read_b128 v[96:99], v18 offset:3584
    ds_read_b64 v[64:65], v17 offset:0
    ds_read_b64 v[66:67], v17 offset:8
    ds_read_b128 v[100:103], v18 offset:3072
    ds_read_b64 v[68:69], v17 offset:512
    ds_read_b64 v[70:71], v17 offset:520
    ds_read_b128 v[104:107], v18 offset:2560
    ds_read_b64 v[72:73], v17 offset:1024
    ds_read_b64 v[74:75], v17 offset:1032
    ds_read_b128 v[108:111], v18 offset:2048
    ds_read_b64 v[76:77], v17 offset:1536
    ds_read_b64 v[78:79], v17 offset:1544
    ds_read_b128 v[112:115], v18 offset:1536
    ds_read_b64 v[80:81], v17 offset:2048
    ds_read_b64 v[82:83], v17 offset:2056
    ds_read_b128 v[116:119], v18 offset:1024
    ds_read_b64 v[84:85], v17 offset:2560
    ds_read_b64 v[86:87], v17 offset:2568
    ds_read_b128 v[120:123], v18 offset:512
    ds_read_b64 v[88:89], v17 offset:3072
    ds_read_b64 v[90:91], v17 offset:3080
    ds_read_b128 v[124:127], v18 offset:0
    ds_read_b64 v[92:93], v17 offset:3584
    ds_read_b64 v[94:95], v17 offset:3592
    s_waitcnt lgkmcnt(0)
    v_mfma_f32_16x16x32_bf16 v[192:195], v[20:23], v[96:99], 0
    v_mfma_f32_16x16x32_bf16 v[196:199], v[20:23], v[100:103], 0
    v_mfma_f32_16x16x32_bf16 v[200:203], v[20:23], v[104:107], 0
    v_mfma_f32_16x16x32_bf16 v[204:207], v[20:23], v[108:111], 0
    v_mfma_f32_16x16x32_bf16 v[208:211], v[20:23], v[112:115], 0
    v_mfma_f32_16x16x32_bf16 v[212:215], v[20:23], v[116:119], 0
    v_mfma_f32_16x16x32_bf16 v[216:219], v[20:23], v[120:123], 0
    v_mfma_f32_16x16x32_bf16 v[220:223], v[20:23], v[124:127], 0
    s_mov_b32 s62, 4
L_cvf:
    s_waitcnt lgkmcnt(0)
    v_mfma_f32_16x16x32_bf16 v[192:195], v[64:67], v[96:99], v[192:195]
    ds_read_b128 v[160:163], v18 offset:3648
    v_mfma_f32_16x16x32_bf16 v[196:199], v[64:67], v[100:103], v[196:199]
    ds_read_b64 v[128:129], v17 offset:64
    v_mfma_f32_16x16x32_bf16 v[200:203], v[64:67], v[104:107], v[200:203]
    ds_read_b64 v[130:131], v17 offset:72
    v_mfma_f32_16x16x32_bf16 v[204:207], v[64:67], v[108:111], v[204:207]
    ds_read_b128 v[164:167], v18 offset:3136
    v_mfma_f32_16x16x32_bf16 v[208:211], v[64:67], v[112:115], v[208:211]
    ds_read_b64 v[132:133], v17 offset:576
    v_mfma_f32_16x16x32_bf16 v[212:215], v[64:67], v[116:119], v[212:215]
    ds_read_b64 v[134:135], v17 offset:584
    v_mfma_f32_16x16x32_bf16 v[216:219], v[64:67], v[120:123], v[216:219]
    ds_read_b128 v[168:171], v18 offset:2624
    v_mfma_f32_16x16x32_bf16 v[220:223], v[64:67], v[124:127], v[220:223]
    ds_read_b64 v[136:137], v17 offset:1088
    v_mfma_f32_16x16x32_bf16 v[196:199], v[68:71], v[96:99], v[196:199]
    ds_read_b64 v[138:139], v17 offset:1096
    v_mfma_f32_16x16x32_bf16 v[200:203], v[68:71], v[100:103], v[200:203]
    ds_read_b128 v[172:175], v18 offset:2112
    v_mfma_f32_16x16x32_bf16 v[204:207], v[68:71], v[104:107], v[204:207]
    ds_read_b64 v[140:141], v17 offset:1600
    v_mfma_f32_16x16x32_bf16 v[208:211], v[68:71], v[108:111], v[208:211]
    ds_read_b64 v[142:143], v17 offset:1608
    v_mfma_f32_16x16x32_bf16 v[212:215], v[68:71], v[112:115], v[212:215]
    ds_read_b128 v[176:179], v18 offset:1600
    v_mfma_f32_16x16x32_bf16 v[216:219], v[68:71], v[116:119], v[216:219]
    ds_read_b64 v[144:145], v17 offset:2112
    v_mfma_f32_16x16x32_bf16 v[220:223], v[68:71], v[120:123], v[220:223]
    ds_read_b64 v[146:147], v17 offset:2120
    v_mfma_f32_16x16x32_bf16 v[200:203], v[72:75], v[96:99], v[200:203]
    ds_read_b128 v[180:183], v18 offset:1088
    v_mfma_f32_16x16x32_bf16 v[204:207], v[72:75], v[100:103], v[204:207]
    ds_read_b64 v[148:149], v17 offset:2624
    v_mfma_f32_16x16x32_bf16 v[208:211], v[72:75], v[104:107], v[208:211]
    ds_read_b64 v[150:151], v17 offset:2632
    v_mfma_f32_16x16x32_bf16 v[212:215], v[72:75], v[108:111], v[212:215]
    ds_read_b128 v[184:187], v18 offset:576
    v_mfma_f32_16x16x32_bf16 v[216:219], v[72:75], v[112:115], v[216:219]
    ds_read_b64 v[152:153], v17 offset:3136
    v_mfma_f32_16x16x32_bf16 v[220:223], v[72:75], v[116:119], v[220:223]
    ds_read_b64 v[154:155], v17 offset:3144
    v_mfma_f32_16x16x32_bf16 v[204:207], v[76:79], v[96:99], v[204:207]
    ds_read_b128 v[188:191], v18 offset:64
    v_mfma_f32_16x16x32_bf16 v[208:211], v[76:79], v[100:103], v[208:211]
    ds_read_b64 v[156:157], v17 offset:3648
    v_mfma_f32_16x16x32_bf16 v[212:215], v[76:79], v[104:107], v[212:215]
    ds_read_b64 v[158:159], v17 offset:3656
    v_mfma_f32_16x16x32_bf16 v[216:219], v[76:79], v[108:111], v[216:219]
    v_mfma_f32_16x16x32_bf16 v[220:223], v[76:79], v[112:115], v[220:223]
    v_mfma_f32_16x16x32_bf16 v[208:211], v[80:83], v[96:99], v[208:211]
    v_mfma_f32_16x16x32_bf16 v[212:215], v[80:83], v[100:103], v[212:215]
    v_mfma_f32_16x16x32_bf16 v[216:219], v[80:83], v[104:107], v[216:219]
    v_mfma_f32_16x16x32_bf16 v[220:223], v[80:83], v[108:111], v[220:223]
    v_mfma_f32_16x16x32_bf16 v[212:215], v[84:87], v[96:99], v[212:215]
    v_mfma_f32_16x16x32_bf16 v[216:219], v[84:87], v[100:103], v[216:219]
    v_mfma_f32_16x16x32_bf16 v[220:223], v[84:87], v[104:107], v[220:223]
    v_mfma_f32_16x16x32_bf16 v[216:219], v[88:91], v[96:99], v[216:219]
    v_mfma_f32_16x16x32_bf16 v[220:223], v[88:91], v[100:103], v[220:223]
    v_mfma_f32_16x16x32_bf16 v[220:223], v[92:95], v[96:99], v[220:223]
    s_waitcnt lgkmcnt(0)
    v_mfma_f32_16x16x32_bf16 v[192:195], v[128:131], v[160:163], v[192:195]
    ds_read_b128 v[96:99], v18 offset:3712
    v_mfma_f32_16x16x32_bf16 v[196:199], v[128:131], v[164:167], v[196:199]
    ds_read_b64 v[64:65], v17 offset:128
    v_mfma_f32_16x16x32_bf16 v[200:203], v[128:131], v[168:171], v[200:203]
    ds_read_b64 v[66:67], v17 offset:136
    v_mfma_f32_16x16x32_bf16 v[204:207], v[128:131], v[172:175], v[204:207]
    ds_read_b128 v[100:103], v18 offset:3200
    v_mfma_f32_16x16x32_bf16 v[208:211], v[128:131], v[176:179], v[208:211]
    ds_read_b64 v[68:69], v17 offset:640
    v_mfma_f32_16x16x32_bf16 v[212:215], v[128:131], v[180:183], v[212:215]
    ds_read_b64 v[70:71], v17 offset:648
    v_mfma_f32_16x16x32_bf16 v[216:219], v[128:131], v[184:187], v[216:219]
    ds_read_b128 v[104:107], v18 offset:2688
    v_mfma_f32_16x16x32_bf16 v[220:223], v[128:131], v[188:191], v[220:223]
    ds_read_b64 v[72:73], v17 offset:1152
    v_mfma_f32_16x16x32_bf16 v[196:199], v[132:135], v[160:163], v[196:199]
    ds_read_b64 v[74:75], v17 offset:1160
    v_mfma_f32_16x16x32_bf16 v[200:203], v[132:135], v[164:167], v[200:203]
    ds_read_b128 v[108:111], v18 offset:2176
    v_mfma_f32_16x16x32_bf16 v[204:207], v[132:135], v[168:171], v[204:207]
    ds_read_b64 v[76:77], v17 offset:1664
    v_mfma_f32_16x16x32_bf16 v[208:211], v[132:135], v[172:175], v[208:211]
    ds_read_b64 v[78:79], v17 offset:1672
    v_mfma_f32_16x16x32_bf16 v[212:215], v[132:135], v[176:179], v[212:215]
    ds_read_b128 v[112:115], v18 offset:1664
    v_mfma_f32_16x16x32_bf16 v[216:219], v[132:135], v[180:183], v[216:219]
    ds_read_b64 v[80:81], v17 offset:2176
    v_mfma_f32_16x16x32_bf16 v[220:223], v[132:135], v[184:187], v[220:223]
    ds_read_b64 v[82:83], v17 offset:2184
    v_mfma_f32_16x16x32_bf16 v[200:203], v[136:139], v[160:163], v[200:203]
    ds_read_b128 v[116:119], v18 offset:1152
    v_mfma_f32_16x16x32_bf16 v[204:207], v[136:139], v[164:167], v[204:207]
    ds_read_b64 v[84:85], v17 offset:2688
    v_mfma_f32_16x16x32_bf16 v[208:211], v[136:139], v[168:171], v[208:211]
    ds_read_b64 v[86:87], v17 offset:2696
    v_mfma_f32_16x16x32_bf16 v[212:215], v[136:139], v[172:175], v[212:215]
    ds_read_b128 v[120:123], v18 offset:640
    v_mfma_f32_16x16x32_bf16 v[216:219], v[136:139], v[176:179], v[216:219]
    ds_read_b64 v[88:89], v17 offset:3200
    v_mfma_f32_16x16x32_bf16 v[220:223], v[136:139], v[180:183], v[220:223]
    ds_read_b64 v[90:91], v17 offset:3208
    v_mfma_f32_16x16x32_bf16 v[204:207], v[140:143], v[160:163], v[204:207]
    ds_read_b128 v[124:127], v18 offset:128
    v_mfma_f32_16x16x32_bf16 v[208:211], v[140:143], v[164:167], v[208:211]
    ds_read_b64 v[92:93], v17 offset:3712
    v_mfma_f32_16x16x32_bf16 v[212:215], v[140:143], v[168:171], v[212:215]
    ds_read_b64 v[94:95], v17 offset:3720
    v_mfma_f32_16x16x32_bf16 v[216:219], v[140:143], v[172:175], v[216:219]
    v_mfma_f32_16x16x32_bf16 v[220:223], v[140:143], v[176:179], v[220:223]
    v_mfma_f32_16x16x32_bf16 v[208:211], v[144:147], v[160:163], v[208:211]
    v_mfma_f32_16x16x32_bf16 v[212:215], v[144:147], v[164:167], v[212:215]
    v_mfma_f32_16x16x32_bf16 v[216:219], v[144:147], v[168:171], v[216:219]
    v_mfma_f32_16x16x32_bf16 v[220:223], v[144:147], v[172:175], v[220:223]
    v_mfma_f32_16x16x32_bf16 v[212:215], v[148:151], v[160:163], v[212:215]
    v_mfma_f32_16x16x32_bf16 v[216:219], v[148:151], v[164:167], v[216:219]
    v_mfma_f32_16x16x32_bf16 v[220:223], v[148:151], v[168:171], v[220:223]
    v_mfma_f32_16x16x32_bf16 v[216:219], v[152:155], v[160:163], v[216:219]
    v_mfma_f32_16x16x32_bf16 v[220:223], v[152:155], v[164:167], v[220:223]
    v_mfma_f32_16x16x32_bf16 v[220:223], v[156:159], v[160:163], v[220:223]
    v_add_u32 v17, 128, v17
    v_add_u32 v18, 128, v18
    s_sub_u32 s62, s62, 1
    s_cmp_lg_u32 s62, 0
    s_cbranch_scc1 L_cvf
    v_lshlrev_b32 v8, 5, v7
    v_lshl_add_u32 v8, v6, 3, v8
    v_add_u32 v8, s95, v8
    s_add_u32 s60, s96, 3670016
    s_lshl_b32 s62, s58, 4
    s_add_u32 s91, s62, 851968
    s_waitcnt lgkmcnt(0)
    v_cvt_pk_bf16_f32 v128, v192, v193
    v_cvt_pk_bf16_f32 v129, v194, v195
    ds_write_b64 v8, v[128:129] offset:0
    v_cvt_pk_bf16_f32 v130, v196, v197
    v_cvt_pk_bf16_f32 v131, v198, v199
    ds_write_b64 v8, v[130:131] offset:512
    v_cvt_pk_bf16_f32 v132, v200, v201
    v_cvt_pk_bf16_f32 v133, v202, v203
    ds_write_b64 v8, v[132:133] offset:1024
    v_cvt_pk_bf16_f32 v134, v204, v205
    v_cvt_pk_bf16_f32 v135, v206, v207
    ds_write_b64 v8, v[134:135] offset:1536
    v_cvt_pk_bf16_f32 v136, v208, v209
    v_cvt_pk_bf16_f32 v137, v210, v211
    ds_write_b64 v8, v[136:137] offset:2048
    v_cvt_pk_bf16_f32 v138, v212, v213
    v_cvt_pk_bf16_f32 v139, v214, v215
    ds_write_b64 v8, v[138:139] offset:2560
    v_cvt_pk_bf16_f32 v140, v216, v217
    v_cvt_pk_bf16_f32 v141, v218, v219
    ds_write_b64 v8, v[140:141] offset:3072
    v_cvt_pk_bf16_f32 v142, v220, v221
    v_cvt_pk_bf16_f32 v143, v222, v223
    ds_write_b64 v8, v[142:143] offset:3584
    s_waitcnt lgkmcnt(0)
    ds_read_b128 v[160:163], v16 offset:0
    ds_read_b128 v[164:167], v16 offset:1024
    ds_read_b128 v[168:171], v16 offset:2048
    ds_read_b128 v[172:175], v16 offset:3072
    s_waitcnt lgkmcnt(3)
    buffer_store_dwordx4 v[160:163], v2, s[36:39], s60 offen offset:0 sc1
    s_waitcnt lgkmcnt(2)
    buffer_store_dwordx4 v[164:167], v2, s[36:39], s60 offen offset:1024 sc1
    s_waitcnt lgkmcnt(1)
    buffer_store_dwordx4 v[168:171], v2, s[36:39], s60 offen offset:2048 sc1
    s_waitcnt lgkmcnt(0)
    buffer_store_dwordx4 v[172:175], v2, s[36:39], s60 offen offset:3072 sc1
    s_mov_b32 s99, 100
    v_mov_b32 v29, 100
    ds_write_b32 v27, v29
    s_waitcnt vmcnt(0)
    s_mov_b64 exec, 1
    buffer_store_dwordx2 v[24:25], v26, s[36:39], s91 offen sc1
    s_mov_b64 exec, -1
    s_add_u32 s91, s91, 10240
    s_mov_b64 exec, 1
    buffer_store_dwordx2 v[24:25], v26, s[36:39], s91 offen sc1
    s_mov_b64 exec, -1
    s_mov_b32 s91, 0x80000000
    s_mov_b32 s98, 98304
    s_mov_b32 s19, 86016
    v_and_b32 v4, 3, v1
    v_lshlrev_b32 v4, 2, v4
    v_add_u32 v4, 163808, v4
    s_mov_b32 s59, 1000000
L_lw_cdone_93:
    ds_read_b32 v29, v4
    s_waitcnt lgkmcnt(0)
    v_cmp_gt_u32 vcc, 1, v29
    s_cbranch_vccz L_lwd_cdone_94
    s_sleep 1
    s_sub_u32 s59, s59, 1
    s_cbranch_scc0 L_lw_cdone_93
L_lwd_cdone_94:
    s_branch L_lg2
L_fin:
L_end:
    s_endpgm

.section .rodata,"a"
.p2align 6
.amdhsa_kernel recurrent_scan__ssm_conv_h3__dense_activation_relu__prompt_kernel
  .amdhsa_next_free_vgpr 256
  .amdhsa_next_free_sgpr 102
  .amdhsa_accum_offset 256
  .amdhsa_group_segment_fixed_size 0
  .amdhsa_kernarg_size 96
  .amdhsa_user_sgpr_count 2
  .amdhsa_user_sgpr_kernarg_segment_ptr 1
  .amdhsa_system_sgpr_workgroup_id_x 1
.end_amdhsa_kernel
```
